```python
import torch

def _softmax(x, axis=-1):
    return torch.softmax(x, dim=axis)
def _gelu(x):
    return torch.nn.functional.gelu(x, approximate="tanh")
def _silu(x):
    return torch.nn.functional.silu(x)
def _sigmoid(x):
    return torch.sigmoid(x)
def _layernorm(x, axis=-1, eps=1e-5):
    m = x.mean(dim=axis, keepdim=True)
    v = x.var(dim=axis, keepdim=True, unbiased=False)
    return (x - m) / torch.sqrt(v + eps)
def _scatter_add(tgt, idx, src, axis=0):
    return tgt.clone().index_add_(axis, idx, src)
def _segment_sum(src, seg, n):
    out = torch.zeros((n,) + src.shape[1:], dtype=src.dtype)
    return out.index_add_(0, seg, src)
def _pad(x, pw):
    flat = tuple(v for pair in reversed(pw) for v in pair)
    return torch.nn.functional.pad(x, flat)

kernel_name = 'standalone__molecular_angular_gemnet__graph'

def setup_inputs():

    _w = (lambda a: (lambda t: t.to(torch.bfloat16) if t.is_floating_point() else t)(torch.as_tensor(a)))
    N, deg, De, L = 10000, 16, 16, 2
    E = N * deg
    T = E * deg
    NR = 8
    dist = torch.rand(E).to(float)
    angle = (torch.rand(T) * torch.pi).to(float)
    centers = torch.linspace(0.0, 1.0, NR).to(float)
    ang_freq = torch.arange(1, L + 1).to(float)
    return {
        "m": _w((lambda *s: torch.randn(*s, dtype=torch.bfloat16) * 0.05)(E, De)),
        "idx_in": _w((lambda lo, hi, *s: torch.randint(lo, hi, s))(0, E, T).to(torch.int64)),
        "idx_out": _w((lambda lo, hi, *s: torch.randint(lo, hi, s))(0, E, T).to(torch.int64)),
        "dist": _w(dist),
        "angle": _w(angle),
        "centers": _w(centers),
        "ang_freq": _w(ang_freq),
        "w_rbf": _w((lambda *s: torch.randn(*s, dtype=torch.bfloat16) * 0.2)(NR, De)),
        "w_sbf": _w((lambda *s: torch.randn(*s, dtype=torch.bfloat16) * 0.2)(NR * L, De)),
        "w_down": _w((lambda *s: torch.randn(*s, dtype=torch.bfloat16) * 0.2)(De, De)),
        "w_up": _w((lambda *s: torch.randn(*s, dtype=torch.bfloat16) * 0.2)(De, De)),
    }

def reference(m, idx_in, idx_out, dist, angle, centers, ang_freq, w_rbf, w_sbf, w_down, w_up):
    E, De = m.shape[0], m.shape[1]
    NR = centers.shape[0]
    L = ang_freq.shape[0]
    rbf = torch.exp(-10.0 * (dist[:, None] - centers[None, :]) ** 2)
    cbf = torch.cos(ang_freq[None, :] * angle[:, None])
    rbf_t = rbf[idx_out]
    sbf = torch.reshape(rbf_t[:, :, None] * cbf[:, None, :], (-1, NR * L))
    x = (m[idx_in] @ w_down) * (sbf @ w_sbf)
    agg = _segment_sum(x, idx_out, E)
    return m + (agg @ w_up) * (rbf @ w_rbf)
```

```asm
; @launch grid=(256,1,1) block=(512,1,1) lds=145408
.amdgcn_target "amdgcn-amd-amdhsa--gfx950"
.text
    .globl standalone__molecular_angular_gemnet__graph_kernel
    .p2align 8
    .type standalone__molecular_angular_gemnet__graph_kernel,@function
standalone__molecular_angular_gemnet__graph_kernel:
    s_cmp_ge_u32 s2, 256
    s_cbranch_scc1 standalone__molecular_angular_gemnet__graph_kernel_end
    s_load_dwordx16 s[4:19], s[0:1], 0
    s_load_dwordx8 s[20:27], s[0:1], 64
    s_load_dwordx4 s[28:31], s[0:1], 96
    s_memrealtime s[100:101]
    v_lshrrev_b32 v1, 6, v0
    v_and_b32 v0, 63, v0
    v_readfirstlane_b32 s60, v1
    s_mul_i32 s62, s60, 5120
    v_lshlrev_b32 v220, 4, v0
    v_add_u32 v220, s62, v220
    v_lshrrev_b32 v221, 1, v220
    s_mul_i32 s86, s2, 40000
    s_mul_i32 s87, s2, 20000
    s_cmp_eq_u32 s60, 7
    s_cselect_b64 s[88:89], 15, -1
    s_mul_i32 s67, s2, 625
    s_mul_i32 s62, s60, 80
    s_add_u32 s67, s67, s62
    s_waitcnt lgkmcnt(0)
    s_mov_b32 s40, s8
    s_mov_b32 s41, s9
    s_mov_b32 s42, 10240000
    s_mov_b32 s43, 0x00020000
    s_mov_b32 s36, s6
    s_mov_b32 s37, s7
    s_mov_b32 s38, 10240000
    s_mov_b32 s39, 0x00020000
    s_mov_b32 s48, s12
    s_mov_b32 s49, s13
    s_mov_b32 s50, 5120000
    s_mov_b32 s51, 0x00020000
    s_add_u32 s64, s86, 0
    buffer_load_dwordx4 v[130:133], v220, s[40:43], s64 offen
    s_add_u32 s64, s86, 0
    buffer_load_dwordx4 v[126:129], v220, s[36:39], s64 offen
    s_add_u32 s64, s87, 0
    buffer_load_dwordx2 v[134:135], v221, s[48:51], s64 offen
    s_add_u32 s64, s86, 1024
    buffer_load_dwordx4 v[140:143], v220, s[40:43], s64 offen
    s_add_u32 s64, s86, 1024
    buffer_load_dwordx4 v[136:139], v220, s[36:39], s64 offen
    s_add_u32 s64, s87, 512
    buffer_load_dwordx2 v[144:145], v221, s[48:51], s64 offen
    s_mov_b32 s66, s100
    v_mov_b32 v224, -1
    v_mov_b32 v225, -1
    v_mov_b32 v226, -1
    v_mov_b32 v227, -1
    s_mul_i32 s62, s60, 15744
    s_add_u32 s62, s62, 19456
    v_lshlrev_b32 v228, 4, v0
    v_add_u32 v229, s62, v228
    ds_write_b128 v229, v[224:227] offset:0
    ds_write_b128 v229, v[224:227] offset:1024
    ds_write_b128 v229, v[224:227] offset:2048
    ds_write_b128 v229, v[224:227] offset:3072
    ds_write_b128 v229, v[224:227] offset:4096
    ds_write_b128 v229, v[224:227] offset:5120
    ds_write_b128 v229, v[224:227] offset:6144
    ds_write_b128 v229, v[224:227] offset:7168
    ds_write_b128 v229, v[224:227] offset:8192
    ds_write_b128 v229, v[224:227] offset:9216
    ds_write_b128 v229, v[224:227] offset:10240
    ds_write_b128 v229, v[224:227] offset:11264
    ds_write_b128 v229, v[224:227] offset:12288
    ds_write_b128 v229, v[224:227] offset:13312
    ds_write_b128 v229, v[224:227] offset:14336
    s_mov_b64 exec, 0xffffff
    ds_write_b128 v229, v[224:227] offset:15360
    s_mov_b32 exec_lo, -1
    s_mov_b32 exec_hi, 0
    s_movk_i32 s82, 492
    v_mov_b32 v222, s62
    v_mad_u32_u24 v229, v0, s82, v222
    v_mov_b32 v224, 262144
    ds_write_b32 v229, v224 offset:188
    s_mov_b64 exec, -1
    v_mov_b32 v224, 0
    v_mov_b32 v225, 0
    v_mov_b32 v226, 0
    v_mov_b32 v227, 0
    s_lshl_b32 s62, s60, 11
    s_add_u32 s62, s62, 3072
    v_add_u32 v229, s62, v228
    ds_write_b128 v229, v[224:227]
    ds_write_b128 v229, v[224:227] offset:1024
    s_cmp_lg_u32 s60, 0
    s_cbranch_scc1 z_1
    v_lshlrev_b32 v229, 3, v0
    ds_write_b64 v229, v[224:225]
z_1:
    v_mov_b32 v3, 1
    v_mov_b32 v222, 19456
    v_mov_b32 v223, 0x45000000
    s_mov_b32 s85, 0x44fff000
    s_mov_b32 s80, 6871948
    s_movk_i32 s81, -10000
    s_mov_b32 s83, 79999
    s_mov_b32 s84, 262144
    s_mov_b32 s72, 0xffff0000
    s_waitcnt lgkmcnt(0)
    s_barrier
    s_add_u32 s64, s86, 2048
    buffer_load_dwordx4 v[150:153], v220, s[40:43], s64 offen
    s_add_u32 s64, s86, 2048
    buffer_load_dwordx4 v[146:149], v220, s[36:39], s64 offen
    s_add_u32 s64, s87, 1024
    buffer_load_dwordx2 v[154:155], v221, s[48:51], s64 offen
    s_mov_b32 s32, s4
    s_mov_b32 s33, s5
    s_mov_b32 s34, 5120000
    s_mov_b32 s35, 0x00020000
    s_mov_b32 s44, s10
    s_mov_b32 s45, s11
    s_mov_b32 s46, 320000
    s_mov_b32 s47, 0x00020000
    s_mov_b32 s52, s26
    s_mov_b32 s53, s27
    s_mov_b32 s54, 5120000
    s_mov_b32 s55, 0x00020000
    s_mov_b32 s56, s30
    s_mov_b32 s57, s31
    s_mov_b32 s58, 33554432
    s_mov_b32 s59, 0x00020000
    v_mov_b32 v2, 0
    v_mov_b32 v75, 19456
    s_mov_b32 s69, 0x9c400000
    s_mov_b32 s70, 0x4e200000
    s_movk_i32 s71, 1552
    s_mov_b32 s74, 0x00ffffff
    s_lshl_b32 s73, s2, 7
    s_mov_b32 s61, 0
    s_lshr_b64 s[100:101], s[100:101], 8
    s_sub_u32 s68, 3, s100
    s_lshl_b32 s62, s100, 8
    s_xor_b32 s62, s62, s100
    s_lshl_b32 s63, s62, 16
    s_xor_b32 s62, s62, s63
    v_and_b32 v228, 3, v0
    v_lshlrev_b32 v228, 3, v228
    v_lshrrev_b32 v122, v228, s62
    v_lshlrev_b32 v122, 24, v122
    v_mov_b32 v229, 15
    v_lshlrev_b32 v229, v228, v229
    v_xor_b32 v74, 0x0c0c0c0c, v229
    v_lshrrev_b32 v228, 3, v0
    s_lshl_b32 s62, s60, 5
    v_add_u32 v228, s62, v228
    v_and_b32 v229, 7, v0
    v_mad_u32_u24 v232, v228, s82, v222
    v_mad_u32_u24 v230, v229, 12, v232
    v_mad_u32_u24 v231, v229, 3, v232
    v_lshlrev_b32 v123, 15, v228
    v_lshl_add_u32 v123, v229, 4, v123
    s_lshl_b32 s62, s60, 12
    v_lshlrev_b32 v73, 4, v0
    v_add_u32 v73, s62, v73
    v_lshlrev_b32 v124, 7, v0
    v_cmp_gt_u32 vcc, 36, v0
    s_nop 1
    v_cndmask_b32 v124, 1.0, v124, vcc
    s_getreg_b32 s75, hwreg(HW_REG_HW_ID, 13, 2)
    s_getreg_b32 s62, hwreg(HW_REG_HW_ID, 8, 3)
    s_lshl_b32 s75, s75, 3
    s_or_b32 s75, s75, s62
    v_mov_b32 v4, 0
    v_mov_b32 v5, 0
    v_mov_b32 v6, 0
    v_mov_b32 v7, 0
    v_mov_b32 v8, 0
    v_mov_b32 v9, 0
    v_mov_b32 v10, 0
    v_mov_b32 v11, 0
    v_mov_b32 v12, 0
    v_mov_b32 v13, 0
    v_mov_b32 v14, 0
    v_mov_b32 v15, 0
    v_mov_b32 v16, 0
    v_mov_b32 v17, 0
    v_mov_b32 v18, 0
    v_mov_b32 v19, 0
    v_mov_b32 v20, 0
    v_mov_b32 v21, 0
    v_mov_b32 v22, 0
    v_mov_b32 v23, 0
    v_mov_b32 v24, 0
    v_mov_b32 v25, 0
    v_mov_b32 v26, 0
    v_mov_b32 v27, 0
    v_mov_b32 v28, 0
    v_mov_b32 v29, 0
    v_mov_b32 v30, 0
    v_mov_b32 v31, 0
    v_mov_b32 v32, 0
    v_mov_b32 v33, 0
    v_mov_b32 v34, 0
    v_mov_b32 v35, 0
    v_mov_b32 v36, 0
    v_mov_b32 v37, 0
    v_mov_b32 v38, 0
    v_mov_b32 v39, 0
    v_mov_b32 v40, 0
    v_mov_b32 v41, 0
    v_mov_b32 v42, 0
    v_mov_b32 v43, 0
    v_and_b32 v228, 15, v0
    v_lshrrev_b32 v229, 4, v0
    v_lshlrev_b32 v176, 3, v0
    global_load_dwordx2 v[76:77], v176, s[22:23]
    v_add_u32 v176, s67, v228
    v_lshlrev_b32 v72, 5, v176
    v_lshl_add_u32 v72, v229, 3, v72
    v_lshlrev_b32 v176, 1, v176
    buffer_load_ushort v78, v176, s[44:47], 0 offen offset:0
    buffer_load_ushort v79, v176, s[44:47], 0 offen offset:32
    buffer_load_ushort v80, v176, s[44:47], 0 offen offset:64
    buffer_load_ushort v81, v176, s[44:47], 0 offen offset:96
    buffer_load_ushort v82, v176, s[44:47], 0 offen offset:128
    v_lshlrev_b32 v176, 3, v229
    v_and_b32 v176, 8, v176
    global_load_dwordx2 v[84:85], v176, s[14:15]
    s_and_b32 s63, s60, 3
    s_cmp_eq_u32 s63, 3
    s_cbranch_scc1 ew_5
    s_cmp_eq_u32 s63, 2
    s_cbranch_scc1 ew_4
    v_and_b32 v176, 1, v229
    v_lshlrev_b32 v176, 8, v176
    v_lshl_add_u32 v176, v228, 1, v176
    s_lshl_b32 s62, s63, 5
    v_add_u32 v176, s62, v176
    global_load_ushort v86, v176, s[20:21] offset:0
    global_load_ushort v87, v176, s[20:21] offset:64
    global_load_ushort v88, v176, s[20:21] offset:128
    global_load_ushort v89, v176, s[20:21] offset:192
    s_branch ewx_6
ew_4:
    v_and_b32 v176, 1, v229
    v_lshlrev_b32 v176, 7, v176
    v_lshl_add_u32 v176, v228, 1, v176
    global_load_ushort v86, v176, s[18:19] offset:0
    global_load_ushort v87, v176, s[18:19] offset:32
    global_load_ushort v88, v176, s[18:19] offset:64
    global_load_ushort v89, v176, s[18:19] offset:96
    s_branch ewx_6
ew_5:
    v_lshlrev_b32 v176, 7, v229
    v_lshl_add_u32 v176, v228, 1, v176
    global_load_ushort v86, v176, s[24:25] offset:0
    global_load_ushort v87, v176, s[24:25] offset:32
    global_load_ushort v88, v176, s[24:25] offset:64
    global_load_ushort v89, v176, s[24:25] offset:96
ewx_6:
c_p1:
    s_waitcnt vmcnt(17)
    v_mul_hi_u32_u24 v176, s80, v130
    v_mul_hi_u32_u24 v177, s80, v131
    v_mul_hi_u32_u24 v178, s80, v132
    v_mul_hi_u32_u24 v179, s80, v133
    v_lshlrev_b32 v192, 16, v134
    v_and_b32 v193, s72, v134
    v_lshlrev_b32 v194, 16, v135
    v_and_b32 v195, s72, v135
    v_sub_u32 v180, s83, v126
    v_sub_u32 v181, s83, v127
    v_sub_u32 v182, s83, v128
    v_sub_u32 v183, s83, v129
    v_mul_f32 v192, 0x3e22f983, v192
    v_mul_f32 v193, 0x3e22f983, v193
    v_mul_f32 v194, 0x3e22f983, v194
    v_mul_f32 v195, 0x3e22f983, v195
    v_lshlrev_b32 v130, 4, v130
    v_lshlrev_b32 v131, 4, v131
    v_lshlrev_b32 v132, 4, v132
    v_lshlrev_b32 v133, 4, v133
    v_ashrrev_i32 v180, 31, v180
    v_ashrrev_i32 v181, 31, v181
    v_ashrrev_i32 v182, 31, v182
    v_ashrrev_i32 v183, 31, v183
    v_fract_f32 v192, v192
    v_fract_f32 v193, v193
    v_fract_f32 v194, v194
    v_fract_f32 v195, v195
    v_mad_i32_i24 v130, v176, s81, v130
    v_mad_i32_i24 v131, v177, s81, v131
    v_mad_i32_i24 v132, v178, s81, v132
    v_mad_i32_i24 v133, v179, s81, v133
    v_and_b32 v184, 9, v180
    v_and_b32 v185, 9, v181
    v_and_b32 v186, 9, v182
    v_and_b32 v187, 9, v183
    v_cos_f32 v192, v192
    v_cos_f32 v193, v193
    v_cos_f32 v194, v194
    v_cos_f32 v195, v195
    v_lshl_or_b32 v126, v126, 14, v130
    v_lshl_or_b32 v127, v127, 14, v131
    v_lshl_or_b32 v128, v128, 14, v132
    v_lshl_or_b32 v129, v129, 14, v133
    v_lshl_or_b32 v196, v3, v184, s84
    v_lshl_or_b32 v197, v3, v185, s84
    v_lshl_or_b32 v198, v3, v186, s84
    v_lshl_or_b32 v199, v3, v187, s84
    v_mad_u32_u24 v130, v176, s82, v222
    v_mad_u32_u24 v131, v177, s82, v222
    v_mad_u32_u24 v132, v178, s82, v222
    v_mad_u32_u24 v133, v179, s82, v222
    ds_add_rtn_u32 v188, v130, v196 offset:188
    ds_add_rtn_u32 v189, v131, v197 offset:188
    ds_add_rtn_u32 v190, v132, v198 offset:188
    ds_add_rtn_u32 v191, v133, v199 offset:188
    v_fma_f32 v192, v192, s85, v223
    v_fma_f32 v193, v193, s85, v223
    v_fma_f32 v194, v194, s85, v223
    v_fma_f32 v195, v195, s85, v223
    v_cvt_u32_f32 v192, v192
    v_cvt_u32_f32 v193, v193
    v_cvt_u32_f32 v194, v194
    v_cvt_u32_f32 v195, v195
    v_and_or_b32 v126, v192, 15, v126
    v_and_or_b32 v127, v193, 15, v127
    v_and_or_b32 v128, v194, 15, v128
    v_and_or_b32 v129, v195, 15, v129
    v_lshrrev_b32 v192, 4, v192
    v_lshrrev_b32 v193, 4, v193
    v_lshrrev_b32 v194, 4, v194
    v_lshrrev_b32 v195, 4, v195
    s_add_u32 s64, s86, 3072
    buffer_load_dwordx4 v[160:163], v220, s[40:43], s64 offen
    s_add_u32 s64, s86, 3072
    buffer_load_dwordx4 v[156:159], v220, s[36:39], s64 offen
    s_add_u32 s64, s87, 1536
    buffer_load_dwordx2 v[164:165], v221, s[48:51], s64 offen
    s_waitcnt vmcnt(17)
    v_mul_hi_u32_u24 v176, s80, v140
    v_mul_hi_u32_u24 v177, s80, v141
    v_mul_hi_u32_u24 v178, s80, v142
    v_mul_hi_u32_u24 v179, s80, v143
    v_lshlrev_b32 v212, 16, v144
    v_and_b32 v213, s72, v144
    v_lshlrev_b32 v214, 16, v145
    v_and_b32 v215, s72, v145
    v_sub_u32 v200, s83, v136
    v_sub_u32 v201, s83, v137
    v_sub_u32 v202, s83, v138
    v_sub_u32 v203, s83, v139
    v_mul_f32 v212, 0x3e22f983, v212
    v_mul_f32 v213, 0x3e22f983, v213
    v_mul_f32 v214, 0x3e22f983, v214
    v_mul_f32 v215, 0x3e22f983, v215
    v_lshlrev_b32 v140, 4, v140
    v_lshlrev_b32 v141, 4, v141
    v_lshlrev_b32 v142, 4, v142
    v_lshlrev_b32 v143, 4, v143
    v_ashrrev_i32 v200, 31, v200
    v_ashrrev_i32 v201, 31, v201
    v_ashrrev_i32 v202, 31, v202
    v_ashrrev_i32 v203, 31, v203
    v_fract_f32 v212, v212
    v_fract_f32 v213, v213
    v_fract_f32 v214, v214
    v_fract_f32 v215, v215
    v_mad_i32_i24 v140, v176, s81, v140
    v_mad_i32_i24 v141, v177, s81, v141
    v_mad_i32_i24 v142, v178, s81, v142
    v_mad_i32_i24 v143, v179, s81, v143
    v_and_b32 v204, 9, v200
    v_and_b32 v205, 9, v201
    v_and_b32 v206, 9, v202
    v_and_b32 v207, 9, v203
    v_cos_f32 v212, v212
    v_cos_f32 v213, v213
    v_cos_f32 v214, v214
    v_cos_f32 v215, v215
    v_lshl_or_b32 v136, v136, 14, v140
    v_lshl_or_b32 v137, v137, 14, v141
    v_lshl_or_b32 v138, v138, 14, v142
    v_lshl_or_b32 v139, v139, 14, v143
    v_lshl_or_b32 v216, v3, v204, s84
    v_lshl_or_b32 v217, v3, v205, s84
    v_lshl_or_b32 v218, v3, v206, s84
    v_lshl_or_b32 v219, v3, v207, s84
    v_mad_u32_u24 v140, v176, s82, v222
    v_mad_u32_u24 v141, v177, s82, v222
    v_mad_u32_u24 v142, v178, s82, v222
    v_mad_u32_u24 v143, v179, s82, v222
    ds_add_rtn_u32 v208, v140, v216 offset:188
    ds_add_rtn_u32 v209, v141, v217 offset:188
    ds_add_rtn_u32 v210, v142, v218 offset:188
    ds_add_rtn_u32 v211, v143, v219 offset:188
    v_fma_f32 v212, v212, s85, v223
    v_fma_f32 v213, v213, s85, v223
    v_fma_f32 v214, v214, s85, v223
    v_fma_f32 v215, v215, s85, v223
    v_cvt_u32_f32 v212, v212
    v_cvt_u32_f32 v213, v213
    v_cvt_u32_f32 v214, v214
    v_cvt_u32_f32 v215, v215
    v_and_or_b32 v136, v212, 15, v136
    v_and_or_b32 v137, v213, 15, v137
    v_and_or_b32 v138, v214, 15, v138
    v_and_or_b32 v139, v215, 15, v139
    v_lshrrev_b32 v212, 4, v212
    v_lshrrev_b32 v213, 4, v213
    v_lshrrev_b32 v214, 4, v214
    v_lshrrev_b32 v215, 4, v215
    s_mov_b64 exec, s[88:89]
    s_add_u32 s64, s86, 4096
    buffer_load_dwordx4 v[170:173], v220, s[40:43], s64 offen
    s_add_u32 s64, s86, 4096
    buffer_load_dwordx4 v[166:169], v220, s[36:39], s64 offen
    s_add_u32 s64, s87, 2048
    buffer_load_dwordx2 v[174:175], v221, s[48:51], s64 offen
    s_mov_b64 exec, -1
    s_waitcnt lgkmcnt(4)
    v_bfe_u32 v184, v188, v184, 9
    v_bfe_u32 v185, v189, v185, 9
    v_bfe_u32 v186, v190, v186, 9
    v_bfe_u32 v187, v191, v187, 9
    v_and_b32 v196, 47, v180
    v_and_b32 v197, 47, v181
    v_and_b32 v198, 47, v182
    v_and_b32 v199, 47, v183
    v_lshrrev_b32 v188, 18, v188
    v_lshrrev_b32 v189, 18, v189
    v_lshrrev_b32 v190, 18, v190
    v_lshrrev_b32 v191, 18, v191
    v_xad_u32 v184, v184, v180, v196
    v_xad_u32 v185, v185, v181, v197
    v_xad_u32 v186, v186, v182, v198
    v_xad_u32 v187, v187, v183, v199
    v_cmp_le_u32 s[4:5], 48, v188
    v_cmp_le_u32 s[6:7], 48, v189
    v_cmp_le_u32 s[8:9], 48, v190
    v_cmp_le_u32 s[10:11], 48, v191
    v_cndmask_b32 v184, v184, v188, s[4:5]
    v_cndmask_b32 v185, v185, v189, s[6:7]
    v_cndmask_b32 v186, v186, v190, s[8:9]
    v_cndmask_b32 v187, v187, v191, s[10:11]
    v_min_u32 v184, 96, v184
    v_min_u32 v185, 96, v185
    v_min_u32 v186, 96, v186
    v_min_u32 v187, 96, v187
    v_lshl_add_u32 v196, v184, 2, v130
    v_lshl_add_u32 v197, v185, 2, v131
    v_lshl_add_u32 v198, v186, 2, v132
    v_lshl_add_u32 v199, v187, 2, v133
    v_add_u32 v184, v184, v130
    v_add_u32 v185, v185, v131
    v_add_u32 v186, v186, v132
    v_add_u32 v187, v187, v133
    ds_write_b32 v196, v126
    ds_write_b8 v184, v192 offset:388
    ds_write_b32 v197, v127
    ds_write_b8 v185, v193 offset:388
    ds_write_b32 v198, v128
    ds_write_b8 v186, v194 offset:388
    ds_write_b32 v199, v129
    ds_write_b8 v187, v195 offset:388
    s_waitcnt vmcnt(17)
    v_mul_hi_u32_u24 v176, s80, v150
    v_mul_hi_u32_u24 v177, s80, v151
    v_mul_hi_u32_u24 v178, s80, v152
    v_mul_hi_u32_u24 v179, s80, v153
    v_lshlrev_b32 v192, 16, v154
    v_and_b32 v193, s72, v154
    v_lshlrev_b32 v194, 16, v155
    v_and_b32 v195, s72, v155
    v_sub_u32 v180, s83, v146
    v_sub_u32 v181, s83, v147
    v_sub_u32 v182, s83, v148
    v_sub_u32 v183, s83, v149
    v_mul_f32 v192, 0x3e22f983, v192
    v_mul_f32 v193, 0x3e22f983, v193
    v_mul_f32 v194, 0x3e22f983, v194
    v_mul_f32 v195, 0x3e22f983, v195
    v_lshlrev_b32 v150, 4, v150
    v_lshlrev_b32 v151, 4, v151
    v_lshlrev_b32 v152, 4, v152
    v_lshlrev_b32 v153, 4, v153
    v_ashrrev_i32 v180, 31, v180
    v_ashrrev_i32 v181, 31, v181
    v_ashrrev_i32 v182, 31, v182
    v_ashrrev_i32 v183, 31, v183
    v_fract_f32 v192, v192
    v_fract_f32 v193, v193
    v_fract_f32 v194, v194
    v_fract_f32 v195, v195
    v_mad_i32_i24 v150, v176, s81, v150
    v_mad_i32_i24 v151, v177, s81, v151
    v_mad_i32_i24 v152, v178, s81, v152
    v_mad_i32_i24 v153, v179, s81, v153
    v_and_b32 v184, 9, v180
    v_and_b32 v185, 9, v181
    v_and_b32 v186, 9, v182
    v_and_b32 v187, 9, v183
    v_cos_f32 v192, v192
    v_cos_f32 v193, v193
    v_cos_f32 v194, v194
    v_cos_f32 v195, v195
    v_lshl_or_b32 v146, v146, 14, v150
    v_lshl_or_b32 v147, v147, 14, v151
    v_lshl_or_b32 v148, v148, 14, v152
    v_lshl_or_b32 v149, v149, 14, v153
    v_lshl_or_b32 v196, v3, v184, s84
    v_lshl_or_b32 v197, v3, v185, s84
    v_lshl_or_b32 v198, v3, v186, s84
    v_lshl_or_b32 v199, v3, v187, s84
    v_mad_u32_u24 v150, v176, s82, v222
    v_mad_u32_u24 v151, v177, s82, v222
    v_mad_u32_u24 v152, v178, s82, v222
    v_mad_u32_u24 v153, v179, s82, v222
    s_waitcnt lgkmcnt(8)
    ds_add_rtn_u32 v188, v150, v196 offset:188
    ds_add_rtn_u32 v189, v151, v197 offset:188
    ds_add_rtn_u32 v190, v152, v198 offset:188
    ds_add_rtn_u32 v191, v153, v199 offset:188
    v_fma_f32 v192, v192, s85, v223
    v_fma_f32 v193, v193, s85, v223
    v_fma_f32 v194, v194, s85, v223
    v_fma_f32 v195, v195, s85, v223
    v_cvt_u32_f32 v192, v192
    v_cvt_u32_f32 v193, v193
    v_cvt_u32_f32 v194, v194
    v_cvt_u32_f32 v195, v195
    v_and_or_b32 v146, v192, 15, v146
    v_and_or_b32 v147, v193, 15, v147
    v_and_or_b32 v148, v194, 15, v148
    v_and_or_b32 v149, v195, 15, v149
    v_lshrrev_b32 v192, 4, v192
    v_lshrrev_b32 v193, 4, v193
    v_lshrrev_b32 v194, 4, v194
    v_lshrrev_b32 v195, 4, v195
    s_waitcnt lgkmcnt(4)
    v_bfe_u32 v204, v208, v204, 9
    v_bfe_u32 v205, v209, v205, 9
    v_bfe_u32 v206, v210, v206, 9
    v_bfe_u32 v207, v211, v207, 9
    v_and_b32 v216, 47, v200
    v_and_b32 v217, 47, v201
    v_and_b32 v218, 47, v202
    v_and_b32 v219, 47, v203
    v_lshrrev_b32 v208, 18, v208
    v_lshrrev_b32 v209, 18, v209
    v_lshrrev_b32 v210, 18, v210
    v_lshrrev_b32 v211, 18, v211
    v_xad_u32 v204, v204, v200, v216
    v_xad_u32 v205, v205, v201, v217
    v_xad_u32 v206, v206, v202, v218
    v_xad_u32 v207, v207, v203, v219
    v_cmp_le_u32 s[4:5], 48, v208
    v_cmp_le_u32 s[6:7], 48, v209
    v_cmp_le_u32 s[8:9], 48, v210
    v_cmp_le_u32 s[10:11], 48, v211
    v_cndmask_b32 v204, v204, v208, s[4:5]
    v_cndmask_b32 v205, v205, v209, s[6:7]
    v_cndmask_b32 v206, v206, v210, s[8:9]
    v_cndmask_b32 v207, v207, v211, s[10:11]
    v_min_u32 v204, 96, v204
    v_min_u32 v205, 96, v205
    v_min_u32 v206, 96, v206
    v_min_u32 v207, 96, v207
    v_lshl_add_u32 v216, v204, 2, v140
    v_lshl_add_u32 v217, v205, 2, v141
    v_lshl_add_u32 v218, v206, 2, v142
    v_lshl_add_u32 v219, v207, 2, v143
    v_add_u32 v204, v204, v140
    v_add_u32 v205, v205, v141
    v_add_u32 v206, v206, v142
    v_add_u32 v207, v207, v143
    ds_write_b32 v216, v136
    ds_write_b8 v204, v212 offset:388
    ds_write_b32 v217, v137
    ds_write_b8 v205, v213 offset:388
    ds_write_b32 v218, v138
    ds_write_b8 v206, v214 offset:388
    ds_write_b32 v219, v139
    ds_write_b8 v207, v215 offset:388
    s_waitcnt vmcnt(3)
    v_mul_hi_u32_u24 v176, s80, v160
    v_mul_hi_u32_u24 v177, s80, v161
    v_mul_hi_u32_u24 v178, s80, v162
    v_mul_hi_u32_u24 v179, s80, v163
    v_lshlrev_b32 v212, 16, v164
    v_and_b32 v213, s72, v164
    v_lshlrev_b32 v214, 16, v165
    v_and_b32 v215, s72, v165
    v_sub_u32 v200, s83, v156
    v_sub_u32 v201, s83, v157
    v_sub_u32 v202, s83, v158
    v_sub_u32 v203, s83, v159
    v_mul_f32 v212, 0x3e22f983, v212
    v_mul_f32 v213, 0x3e22f983, v213
    v_mul_f32 v214, 0x3e22f983, v214
    v_mul_f32 v215, 0x3e22f983, v215
    v_lshlrev_b32 v160, 4, v160
    v_lshlrev_b32 v161, 4, v161
    v_lshlrev_b32 v162, 4, v162
    v_lshlrev_b32 v163, 4, v163
    v_ashrrev_i32 v200, 31, v200
    v_ashrrev_i32 v201, 31, v201
    v_ashrrev_i32 v202, 31, v202
    v_ashrrev_i32 v203, 31, v203
    v_fract_f32 v212, v212
    v_fract_f32 v213, v213
    v_fract_f32 v214, v214
    v_fract_f32 v215, v215
    v_mad_i32_i24 v160, v176, s81, v160
    v_mad_i32_i24 v161, v177, s81, v161
    v_mad_i32_i24 v162, v178, s81, v162
    v_mad_i32_i24 v163, v179, s81, v163
    v_and_b32 v204, 9, v200
    v_and_b32 v205, 9, v201
    v_and_b32 v206, 9, v202
    v_and_b32 v207, 9, v203
    v_cos_f32 v212, v212
    v_cos_f32 v213, v213
    v_cos_f32 v214, v214
    v_cos_f32 v215, v215
    v_lshl_or_b32 v156, v156, 14, v160
    v_lshl_or_b32 v157, v157, 14, v161
    v_lshl_or_b32 v158, v158, 14, v162
    v_lshl_or_b32 v159, v159, 14, v163
    v_lshl_or_b32 v216, v3, v204, s84
    v_lshl_or_b32 v217, v3, v205, s84
    v_lshl_or_b32 v218, v3, v206, s84
    v_lshl_or_b32 v219, v3, v207, s84
    v_mad_u32_u24 v160, v176, s82, v222
    v_mad_u32_u24 v161, v177, s82, v222
    v_mad_u32_u24 v162, v178, s82, v222
    v_mad_u32_u24 v163, v179, s82, v222
    s_waitcnt lgkmcnt(8)
    ds_add_rtn_u32 v208, v160, v216 offset:188
    ds_add_rtn_u32 v209, v161, v217 offset:188
    ds_add_rtn_u32 v210, v162, v218 offset:188
    ds_add_rtn_u32 v211, v163, v219 offset:188
    v_fma_f32 v212, v212, s85, v223
    v_fma_f32 v213, v213, s85, v223
    v_fma_f32 v214, v214, s85, v223
    v_fma_f32 v215, v215, s85, v223
    v_cvt_u32_f32 v212, v212
    v_cvt_u32_f32 v213, v213
    v_cvt_u32_f32 v214, v214
    v_cvt_u32_f32 v215, v215
    v_and_or_b32 v156, v212, 15, v156
    v_and_or_b32 v157, v213, 15, v157
    v_and_or_b32 v158, v214, 15, v158
    v_and_or_b32 v159, v215, 15, v159
    v_lshrrev_b32 v212, 4, v212
    v_lshrrev_b32 v213, 4, v213
    v_lshrrev_b32 v214, 4, v214
    v_lshrrev_b32 v215, 4, v215
    s_waitcnt lgkmcnt(4)
    v_bfe_u32 v184, v188, v184, 9
    v_bfe_u32 v185, v189, v185, 9
    v_bfe_u32 v186, v190, v186, 9
    v_bfe_u32 v187, v191, v187, 9
    v_and_b32 v196, 47, v180
    v_and_b32 v197, 47, v181
    v_and_b32 v198, 47, v182
    v_and_b32 v199, 47, v183
    v_lshrrev_b32 v188, 18, v188
    v_lshrrev_b32 v189, 18, v189
    v_lshrrev_b32 v190, 18, v190
    v_lshrrev_b32 v191, 18, v191
    v_xad_u32 v184, v184, v180, v196
    v_xad_u32 v185, v185, v181, v197
    v_xad_u32 v186, v186, v182, v198
    v_xad_u32 v187, v187, v183, v199
    v_cmp_le_u32 s[4:5], 48, v188
    v_cmp_le_u32 s[6:7], 48, v189
    v_cmp_le_u32 s[8:9], 48, v190
    v_cmp_le_u32 s[10:11], 48, v191
    v_cndmask_b32 v184, v184, v188, s[4:5]
    v_cndmask_b32 v185, v185, v189, s[6:7]
    v_cndmask_b32 v186, v186, v190, s[8:9]
    v_cndmask_b32 v187, v187, v191, s[10:11]
    v_min_u32 v184, 96, v184
    v_min_u32 v185, 96, v185
    v_min_u32 v186, 96, v186
    v_min_u32 v187, 96, v187
    v_lshl_add_u32 v196, v184, 2, v150
    v_lshl_add_u32 v197, v185, 2, v151
    v_lshl_add_u32 v198, v186, 2, v152
    v_lshl_add_u32 v199, v187, 2, v153
    v_add_u32 v184, v184, v150
    v_add_u32 v185, v185, v151
    v_add_u32 v186, v186, v152
    v_add_u32 v187, v187, v153
    ds_write_b32 v196, v146
    ds_write_b8 v184, v192 offset:388
    ds_write_b32 v197, v147
    ds_write_b8 v185, v193 offset:388
    ds_write_b32 v198, v148
    ds_write_b8 v186, v194 offset:388
    ds_write_b32 v199, v149
    ds_write_b8 v187, v195 offset:388
    s_waitcnt vmcnt(0)
    s_mov_b64 exec, s[88:89]
    v_mul_hi_u32_u24 v176, s80, v170
    v_mul_hi_u32_u24 v177, s80, v171
    v_mul_hi_u32_u24 v178, s80, v172
    v_mul_hi_u32_u24 v179, s80, v173
    v_lshlrev_b32 v192, 16, v174
    v_and_b32 v193, s72, v174
    v_lshlrev_b32 v194, 16, v175
    v_and_b32 v195, s72, v175
    v_sub_u32 v180, s83, v166
    v_sub_u32 v181, s83, v167
    v_sub_u32 v182, s83, v168
    v_sub_u32 v183, s83, v169
    v_mul_f32 v192, 0x3e22f983, v192
    v_mul_f32 v193, 0x3e22f983, v193
    v_mul_f32 v194, 0x3e22f983, v194
    v_mul_f32 v195, 0x3e22f983, v195
    v_lshlrev_b32 v170, 4, v170
    v_lshlrev_b32 v171, 4, v171
    v_lshlrev_b32 v172, 4, v172
    v_lshlrev_b32 v173, 4, v173
    v_ashrrev_i32 v180, 31, v180
    v_ashrrev_i32 v181, 31, v181
    v_ashrrev_i32 v182, 31, v182
    v_ashrrev_i32 v183, 31, v183
    v_fract_f32 v192, v192
    v_fract_f32 v193, v193
    v_fract_f32 v194, v194
    v_fract_f32 v195, v195
    v_mad_i32_i24 v170, v176, s81, v170
    v_mad_i32_i24 v171, v177, s81, v171
    v_mad_i32_i24 v172, v178, s81, v172
    v_mad_i32_i24 v173, v179, s81, v173
    v_and_b32 v184, 9, v180
    v_and_b32 v185, 9, v181
    v_and_b32 v186, 9, v182
    v_and_b32 v187, 9, v183
    v_cos_f32 v192, v192
    v_cos_f32 v193, v193
    v_cos_f32 v194, v194
    v_cos_f32 v195, v195
    v_lshl_or_b32 v166, v166, 14, v170
    v_lshl_or_b32 v167, v167, 14, v171
    v_lshl_or_b32 v168, v168, 14, v172
    v_lshl_or_b32 v169, v169, 14, v173
    v_lshl_or_b32 v196, v3, v184, s84
    v_lshl_or_b32 v197, v3, v185, s84
    v_lshl_or_b32 v198, v3, v186, s84
    v_lshl_or_b32 v199, v3, v187, s84
    v_mad_u32_u24 v170, v176, s82, v222
    v_mad_u32_u24 v171, v177, s82, v222
    v_mad_u32_u24 v172, v178, s82, v222
    v_mad_u32_u24 v173, v179, s82, v222
    s_waitcnt lgkmcnt(8)
    ds_add_rtn_u32 v188, v170, v196 offset:188
    ds_add_rtn_u32 v189, v171, v197 offset:188
    ds_add_rtn_u32 v190, v172, v198 offset:188
    ds_add_rtn_u32 v191, v173, v199 offset:188
    v_fma_f32 v192, v192, s85, v223
    v_fma_f32 v193, v193, s85, v223
    v_fma_f32 v194, v194, s85, v223
    v_fma_f32 v195, v195, s85, v223
    v_cvt_u32_f32 v192, v192
    v_cvt_u32_f32 v193, v193
    v_cvt_u32_f32 v194, v194
    v_cvt_u32_f32 v195, v195
    v_and_or_b32 v166, v192, 15, v166
    v_and_or_b32 v167, v193, 15, v167
    v_and_or_b32 v168, v194, 15, v168
    v_and_or_b32 v169, v195, 15, v169
    v_lshrrev_b32 v192, 4, v192
    v_lshrrev_b32 v193, 4, v193
    v_lshrrev_b32 v194, 4, v194
    v_lshrrev_b32 v195, 4, v195
    s_mov_b64 exec, -1
    s_getpc_b64 s[16:17]
pc_7:
    s_add_u32 s16, s16, c_gap0-pc_7
    s_addc_u32 s17, s17, 0
    s_lshl_b32 s62, s60, 6
    v_add_u32 v229, s62, v0
    v_mul_u32_u24 v229, 64, v229
    v_min_u32 v229, c_done-c_gap0, v229
    global_load_dword v125, v229, s[16:17]
    s_mul_i32 s75, s75, 36864
    s_mul_i32 s62, s60, 4608
    s_add_u32 s75, s75, s62
    buffer_load_dword v125, v124, s[32:35], s75 offen
    s_add_u32 s75, s75, 4608
    s_waitcnt lgkmcnt(4)
    v_bfe_u32 v204, v208, v204, 9
    v_bfe_u32 v205, v209, v205, 9
    v_bfe_u32 v206, v210, v206, 9
    v_bfe_u32 v207, v211, v207, 9
    v_and_b32 v216, 47, v200
    v_and_b32 v217, 47, v201
    v_and_b32 v218, 47, v202
    v_and_b32 v219, 47, v203
    v_lshrrev_b32 v208, 18, v208
    v_lshrrev_b32 v209, 18, v209
    v_lshrrev_b32 v210, 18, v210
    v_lshrrev_b32 v211, 18, v211
    v_xad_u32 v204, v204, v200, v216
    v_xad_u32 v205, v205, v201, v217
    v_xad_u32 v206, v206, v202, v218
    v_xad_u32 v207, v207, v203, v219
    v_cmp_le_u32 s[4:5], 48, v208
    v_cmp_le_u32 s[6:7], 48, v209
    v_cmp_le_u32 s[8:9], 48, v210
    v_cmp_le_u32 s[10:11], 48, v211
    v_cndmask_b32 v204, v204, v208, s[4:5]
    v_cndmask_b32 v205, v205, v209, s[6:7]
    v_cndmask_b32 v206, v206, v210, s[8:9]
    v_cndmask_b32 v207, v207, v211, s[10:11]
    v_min_u32 v204, 96, v204
    v_min_u32 v205, 96, v205
    v_min_u32 v206, 96, v206
    v_min_u32 v207, 96, v207
    v_lshl_add_u32 v216, v204, 2, v160
    v_lshl_add_u32 v217, v205, 2, v161
    v_lshl_add_u32 v218, v206, 2, v162
    v_lshl_add_u32 v219, v207, 2, v163
    v_add_u32 v204, v204, v160
    v_add_u32 v205, v205, v161
    v_add_u32 v206, v206, v162
    v_add_u32 v207, v207, v163
    ds_write_b32 v216, v156
    ds_write_b8 v204, v212 offset:388
    ds_write_b32 v217, v157
    ds_write_b8 v205, v213 offset:388
    ds_write_b32 v218, v158
    ds_write_b8 v206, v214 offset:388
    ds_write_b32 v219, v159
    ds_write_b8 v207, v215 offset:388
    s_waitcnt lgkmcnt(0)
    s_mov_b64 exec, s[88:89]
    v_bfe_u32 v184, v188, v184, 9
    v_bfe_u32 v185, v189, v185, 9
    v_bfe_u32 v186, v190, v186, 9
    v_bfe_u32 v187, v191, v187, 9
    v_and_b32 v196, 47, v180
    v_and_b32 v197, 47, v181
    v_and_b32 v198, 47, v182
    v_and_b32 v199, 47, v183
    v_lshrrev_b32 v188, 18, v188
    v_lshrrev_b32 v189, 18, v189
    v_lshrrev_b32 v190, 18, v190
    v_lshrrev_b32 v191, 18, v191
    v_xad_u32 v184, v184, v180, v196
    v_xad_u32 v185, v185, v181, v197
    v_xad_u32 v186, v186, v182, v198
    v_xad_u32 v187, v187, v183, v199
    v_cmp_le_u32 s[4:5], 48, v188
    v_cmp_le_u32 s[6:7], 48, v189
    v_cmp_le_u32 s[8:9], 48, v190
    v_cmp_le_u32 s[10:11], 48, v191
    v_cndmask_b32 v184, v184, v188, s[4:5]
    v_cndmask_b32 v185, v185, v189, s[6:7]
    v_cndmask_b32 v186, v186, v190, s[8:9]
    v_cndmask_b32 v187, v187, v191, s[10:11]
    v_min_u32 v184, 96, v184
    v_min_u32 v185, 96, v185
    v_min_u32 v186, 96, v186
    v_min_u32 v187, 96, v187
    v_lshl_add_u32 v196, v184, 2, v170
    v_lshl_add_u32 v197, v185, 2, v171
    v_lshl_add_u32 v198, v186, 2, v172
    v_lshl_add_u32 v199, v187, 2, v173
    v_add_u32 v184, v184, v170
    v_add_u32 v185, v185, v171
    v_add_u32 v186, v186, v172
    v_add_u32 v187, v187, v173
    ds_write_b32 v196, v166
    ds_write_b8 v184, v192 offset:388
    ds_write_b32 v197, v167
    ds_write_b8 v185, v193 offset:388
    ds_write_b32 v198, v168
    ds_write_b8 v186, v194 offset:388
    ds_write_b32 v199, v169
    ds_write_b8 v187, v195 offset:388
    s_mov_b64 exec, -1
    s_waitcnt lgkmcnt(0)
    s_barrier
    s_waitcnt vmcnt(8)
    v_and_b32 v184, -4, v231
    v_add_u32 v184, 388, v184
    v_mov_b32 v180, v230
    v_add_u32 v181, 3936, v230
    v_add_u32 v185, 3936, v184
    v_add_u32 v182, 7872, v230
    v_add_u32 v186, 7872, v184
    v_add_u32 v183, 11808, v230
    v_add_u32 v187, 11808, v184
    ds_read2_b32 v[234:235], v180 offset0:0 offset1:1
    ds_read_b32 v236, v180 offset:8
    ds_read2_b32 v[126:127], v184 offset0:0 offset1:1
    ds_read2_b32 v[238:239], v181 offset0:0 offset1:1
    ds_read_b32 v240, v181 offset:8
    ds_read2_b32 v[128:129], v185 offset0:0 offset1:1
    ds_read2_b32 v[242:243], v182 offset0:0 offset1:1
    ds_read_b32 v244, v182 offset:8
    ds_read2_b32 v[130:131], v186 offset0:0 offset1:1
    ds_read2_b32 v[246:247], v183 offset0:0 offset1:1
    ds_read_b32 v248, v183 offset:8
    ds_read2_b32 v[132:133], v187 offset0:0 offset1:1
    s_waitcnt lgkmcnt(6)
    v_alignbyte_b32 v237, v127, v126, v231
    v_bfi_b32 v237, s74, v237, v122
    v_alignbyte_b32 v241, v129, v128, v231
    v_bfi_b32 v241, s74, v241, v122
    s_add_u32 s76, s73, 0
    buffer_store_dwordx4 v[234:237], v123, s[56:59], s76 offen sc1
    ds_read2_b32 v[90:91], v180 offset0:24 offset1:25
    ds_read_b32 v92, v180 offset:104
    ds_read2_b32 v[136:137], v184 offset0:6 offset1:7
    ds_read2_b32 v[94:95], v181 offset0:24 offset1:25
    ds_read_b32 v96, v181 offset:104
    ds_read2_b32 v[138:139], v185 offset0:6 offset1:7
    s_add_u32 s76, s73, 262144
    buffer_store_dwordx4 v[238:241], v123, s[56:59], s76 offen sc1
    s_waitcnt lgkmcnt(6)
    v_alignbyte_b32 v245, v131, v130, v231
    v_bfi_b32 v245, s74, v245, v122
    v_alignbyte_b32 v249, v133, v132, v231
    v_bfi_b32 v249, s74, v249, v122
    s_add_u32 s76, s73, 524288
    buffer_store_dwordx4 v[242:245], v123, s[56:59], s76 offen sc1
    s_add_u32 s76, s73, 786432
    buffer_store_dwordx4 v[246:249], v123, s[56:59], s76 offen sc1
    ds_read2_b32 v[98:99], v182 offset0:24 offset1:25
    ds_read_b32 v100, v182 offset:104
    ds_read2_b32 v[140:141], v186 offset0:6 offset1:7
    ds_read2_b32 v[102:103], v183 offset0:24 offset1:25
    ds_read_b32 v104, v183 offset:104
    ds_read2_b32 v[142:143], v187 offset0:6 offset1:7
    s_waitcnt lgkmcnt(6)
    ds_read_b32 v250, v232 offset:188
    ds_read_b32 v251, v232 offset:4124
    ds_read_b32 v252, v232 offset:8060
    ds_read_b32 v253, v232 offset:11996
    ds_read2_b32 v[106:107], v180 offset0:48 offset1:49
    ds_read_b32 v108, v180 offset:200
    ds_read2_b32 v[146:147], v184 offset0:12 offset1:13
    s_waitcnt lgkmcnt(3)
    ds_read2_b32 v[110:111], v181 offset0:48 offset1:49
    ds_read_b32 v112, v181 offset:200
    ds_read2_b32 v[148:149], v185 offset0:12 offset1:13
    ds_read2_b32 v[114:115], v182 offset0:48 offset1:49
    ds_read_b32 v116, v182 offset:200
    ds_read2_b32 v[150:151], v186 offset0:12 offset1:13
    ds_read2_b32 v[118:119], v183 offset0:48 offset1:49
    ds_read_b32 v120, v183 offset:200
    ds_read2_b32 v[152:153], v187 offset0:12 offset1:13
    s_mov_b32 s62, 12845056
    s_mov_b32 s63, 19136512
    v_cmp_le_u32 s[0:1], s62, v250
    v_cmp_le_u32 s[44:45], s62, v251
    v_cmp_le_u32 s[46:47], s62, v252
    v_cmp_le_u32 s[78:79], s62, v253
    v_max3_u32 v228, v250, v251, v252
    v_max_u32 v228, v228, v253
    v_cmp_le_u32 vcc, s63, v228
    v_alignbyte_b32 v93, v137, v136, v231
    v_bfi_b32 v93, s74, v93, v122
    v_alignbyte_b32 v97, v139, v138, v231
    v_bfi_b32 v97, s74, v97, v122
    v_alignbyte_b32 v101, v141, v140, v231
    v_bfi_b32 v101, s74, v101, v122
    v_alignbyte_b32 v105, v143, v142, v231
    v_bfi_b32 v105, s74, v105, v122
    s_waitcnt lgkmcnt(0)
    v_alignbyte_b32 v109, v147, v146, v231
    v_bfi_b32 v109, s74, v109, v122
    v_alignbyte_b32 v113, v149, v148, v231
    v_bfi_b32 v113, s74, v113, v122
    v_alignbyte_b32 v117, v151, v150, v231
    v_bfi_b32 v117, s74, v117, v122
    v_alignbyte_b32 v121, v153, v152, v231
    v_bfi_b32 v121, s74, v121, v122
    s_cbranch_vccnz p_rare
p_rare_back:
    buffer_load_dwordx2 v[62:63], v72, s[32:35], 0 offen offset:0
    buffer_load_dwordx2 v[64:65], v72, s[32:35], 0 offen offset:512
    buffer_load_dwordx2 v[66:67], v72, s[32:35], 0 offen offset:1024
    buffer_load_dwordx2 v[68:69], v72, s[32:35], 0 offen offset:1536
    buffer_load_dwordx2 v[70:71], v72, s[32:35], 0 offen offset:2048
    s_barrier
    s_add_u32 s76, s73, 8388608
    buffer_store_dwordx4 v[90:93], v123, s[56:59], s76 offen sc1
c_gap0:
    v_and_b32 v213, 15, v0
    v_lshrrev_b32 v214, 4, v0
    v_lshrrev_b32 v215, 2, v213
    v_lshlrev_b32 v215, 3, v215
    v_and_b32 v216, 3, v213
    v_add_u32 v194, v215, v216
    v_lshrrev_b32 v216, 5, v0
    v_lshl_add_u32 v194, v216, 2, v194
    v_add_u32 v195, 32, v194
    v_add_u32 v196, 64, v194
    v_add_u32 v197, 96, v194
    v_add_u32 v198, 128, v194
    v_add_u32 v199, 160, v194
    v_and_b32 v215, 1, v214
    v_lshlrev_b32 v200, 4, v215
    v_lshlrev_b32 v192, 4, v200
    v_lshl_add_u32 v192, v213, 1, v192
    s_mul_i32 s62, s60, 15520
    s_add_u32 s62, s62, 19456
    v_lshlrev_b32 v201, 3, v194
    v_add_u32 v201, s62, v201
    v_add_u32 v202, 1552, v201
    v_and_b32 v215, 31, v0
    v_lshlrev_b32 v203, 3, v215
    v_add_u32 v203, s62, v203
    v_add_u32 v204, 1552, v203
    s_lshl_b32 s62, s60, 11
    s_add_u32 s62, s62, 3072
    v_lshlrev_b32 v209, 4, v0
    v_add_u32 v209, s62, v209
    v_lshrrev_b32 v208, 3, v215
    v_lshlrev_b32 v208, 8, v208
    v_and_b32 v215, 7, v215
    v_lshl_add_u32 v208, v215, 1, v208
    v_lshl_add_u32 v208, v216, 10, v208
    v_add_u32 v208, s62, v208
    v_min_u32 v211, 4, v0
    s_mul_i32 s62, s60, 5
    v_add_u32 v211, s62, v211
    v_lshlrev_b32 v211, 3, v211
    s_mov_b32 s91, 0xf0
    s_mov_b32 s92, 0xffffffe0
    s_mov_b32 s93, 0x3a000801
    v_mov_b32 v210, 0xbf800000
    s_mov_b32 s24, 0
    s_mov_b32 s25, -1
    s_mov_b32 s26, 0x80808080
    s_mov_b32 s27, 0x80808080
    v_lshlrev_b32 v215, 3, v0
    ds_write_b64 v215, v[76:77] offset:512
    ds_read_u16 v158, v192 offset:512
    ds_read_u16 v162, v192 offset:544
    ds_read_u16 v159, v192 offset:576
    ds_read_u16 v163, v192 offset:608
    ds_read_u16 v160, v192 offset:640
    ds_read_u16 v164, v192 offset:672
    ds_read_u16 v161, v192 offset:704
    ds_read_u16 v165, v192 offset:736
    s_and_b32 s63, s60, 3
    s_cmp_lg_u32 s63, 1
    s_cbranch_scc1 nd_8
    v_lshlrev_b32 v86, 16, v86
    v_lshlrev_b32 v87, 16, v87
    v_lshlrev_b32 v88, 16, v88
    v_lshlrev_b32 v89, 16, v89
    v_add_f32 v86, v86, v86
    v_add_f32 v87, v87, v87
    v_add_f32 v88, v88, v88
    v_add_f32 v89, v89, v89
    v_lshrrev_b32 v86, 16, v86
    v_lshrrev_b32 v87, 16, v87
    v_lshrrev_b32 v88, 16, v88
    v_lshrrev_b32 v89, 16, v89
nd_8:
    v_lshl_or_b32 v86, v87, 16, v86
    v_lshl_or_b32 v88, v89, 16, v88
    v_mov_b32 v87, v88
    s_lshl_b32 s62, s63, 9
    v_lshl_add_u32 v215, v0, 3, s62
    ds_write_b64 v215, v[86:87] offset:1024
    v_lshlrev_b32 v150, 16, v84
    v_and_b32 v151, s72, v84
    v_lshlrev_b32 v152, 16, v85
    v_and_b32 v153, s72, v85
    s_not_b64 s[16:17], s[24:25]
    v_lshlrev_b32 v222, 16, v78
    v_sub_f32 v217, v222, v150
    v_sub_f32 v218, v222, v151
    v_sub_f32 v219, v222, v152
    v_sub_f32 v220, v222, v153
    v_cvt_pk_bf16_f32 v221, v217, v218
    v_lshlrev_b32 v217, 16, v221
    v_and_b32 v218, 0xffff0000, v221
    v_cvt_pk_bf16_f32 v221, v219, v220
    v_lshlrev_b32 v219, 16, v221
    v_and_b32 v220, 0xffff0000, v221
    v_mul_f32 v217, v217, v217
    v_mul_f32 v218, v218, v218
    v_mul_f32 v219, v219, v219
    v_mul_f32 v220, v220, v220
    v_cvt_pk_bf16_f32 v221, v217, v218
    v_lshlrev_b32 v217, 16, v221
    v_and_b32 v218, 0xffff0000, v221
    v_cvt_pk_bf16_f32 v221, v219, v220
    v_lshlrev_b32 v219, 16, v221
    v_and_b32 v220, 0xffff0000, v221
    v_mul_f32 v217, 0xc1200000, v217
    v_mul_f32 v218, 0xc1200000, v218
    v_mul_f32 v219, 0xc1200000, v219
    v_mul_f32 v220, 0xc1200000, v220
    v_cvt_pk_bf16_f32 v221, v217, v218
    v_lshlrev_b32 v217, 16, v221
    v_and_b32 v218, 0xffff0000, v221
    v_cvt_pk_bf16_f32 v221, v219, v220
    v_lshlrev_b32 v219, 16, v221
    v_and_b32 v220, 0xffff0000, v221
    v_mul_f32 v217, 0x3fb8aa3b, v217
    v_mul_f32 v218, 0x3fb8aa3b, v218
    v_mul_f32 v219, 0x3fb8aa3b, v219
    v_mul_f32 v220, 0x3fb8aa3b, v220
    v_exp_f32 v217, v217
    v_exp_f32 v218, v218
    v_exp_f32 v219, v219
    v_exp_f32 v220, v220
    v_cvt_pk_bf16_f32 v52, v217, v218
    v_cvt_pk_bf16_f32 v53, v219, v220
    v_cndmask_b32 v52, 0, v52, s[16:17]
    v_cndmask_b32 v53, 0, v53, s[16:17]
    v_lshlrev_b32 v222, 16, v79
    v_sub_f32 v217, v222, v150
    v_sub_f32 v218, v222, v151
    v_sub_f32 v219, v222, v152
    v_sub_f32 v220, v222, v153
    v_cvt_pk_bf16_f32 v221, v217, v218
    v_lshlrev_b32 v217, 16, v221
    v_and_b32 v218, 0xffff0000, v221
    v_cvt_pk_bf16_f32 v221, v219, v220
    v_lshlrev_b32 v219, 16, v221
    v_and_b32 v220, 0xffff0000, v221
    v_mul_f32 v217, v217, v217
    v_mul_f32 v218, v218, v218
    v_mul_f32 v219, v219, v219
    v_mul_f32 v220, v220, v220
    v_cvt_pk_bf16_f32 v221, v217, v218
    v_lshlrev_b32 v217, 16, v221
    v_and_b32 v218, 0xffff0000, v221
    v_cvt_pk_bf16_f32 v221, v219, v220
    v_lshlrev_b32 v219, 16, v221
    v_and_b32 v220, 0xffff0000, v221
    v_mul_f32 v217, 0xc1200000, v217
    v_mul_f32 v218, 0xc1200000, v218
    v_mul_f32 v219, 0xc1200000, v219
    v_mul_f32 v220, 0xc1200000, v220
    v_cvt_pk_bf16_f32 v221, v217, v218
    v_lshlrev_b32 v217, 16, v221
    v_and_b32 v218, 0xffff0000, v221
    v_cvt_pk_bf16_f32 v221, v219, v220
    v_lshlrev_b32 v219, 16, v221
    v_and_b32 v220, 0xffff0000, v221
    v_mul_f32 v217, 0x3fb8aa3b, v217
    v_mul_f32 v218, 0x3fb8aa3b, v218
    v_mul_f32 v219, 0x3fb8aa3b, v219
    v_mul_f32 v220, 0x3fb8aa3b, v220
    v_exp_f32 v217, v217
    v_exp_f32 v218, v218
    v_exp_f32 v219, v219
    v_exp_f32 v220, v220
    v_cvt_pk_bf16_f32 v54, v217, v218
    v_cvt_pk_bf16_f32 v55, v219, v220
    v_cndmask_b32 v54, 0, v54, s[16:17]
    v_cndmask_b32 v55, 0, v55, s[16:17]
    v_lshlrev_b32 v222, 16, v80
    v_sub_f32 v217, v222, v150
    v_sub_f32 v218, v222, v151
    v_sub_f32 v219, v222, v152
    v_sub_f32 v220, v222, v153
    v_cvt_pk_bf16_f32 v221, v217, v218
    v_lshlrev_b32 v217, 16, v221
    v_and_b32 v218, 0xffff0000, v221
    v_cvt_pk_bf16_f32 v221, v219, v220
    v_lshlrev_b32 v219, 16, v221
    v_and_b32 v220, 0xffff0000, v221
    v_mul_f32 v217, v217, v217
    v_mul_f32 v218, v218, v218
    v_mul_f32 v219, v219, v219
    v_mul_f32 v220, v220, v220
    v_cvt_pk_bf16_f32 v221, v217, v218
    v_lshlrev_b32 v217, 16, v221
    v_and_b32 v218, 0xffff0000, v221
    v_cvt_pk_bf16_f32 v221, v219, v220
    v_lshlrev_b32 v219, 16, v221
    v_and_b32 v220, 0xffff0000, v221
    v_mul_f32 v217, 0xc1200000, v217
    v_mul_f32 v218, 0xc1200000, v218
    v_mul_f32 v219, 0xc1200000, v219
    v_mul_f32 v220, 0xc1200000, v220
    v_cvt_pk_bf16_f32 v221, v217, v218
    v_lshlrev_b32 v217, 16, v221
    v_and_b32 v218, 0xffff0000, v221
    v_cvt_pk_bf16_f32 v221, v219, v220
    v_lshlrev_b32 v219, 16, v221
    v_and_b32 v220, 0xffff0000, v221
    v_mul_f32 v217, 0x3fb8aa3b, v217
    v_mul_f32 v218, 0x3fb8aa3b, v218
    v_mul_f32 v219, 0x3fb8aa3b, v219
    v_mul_f32 v220, 0x3fb8aa3b, v220
    v_exp_f32 v217, v217
    v_exp_f32 v218, v218
    v_exp_f32 v219, v219
    v_exp_f32 v220, v220
    v_cvt_pk_bf16_f32 v56, v217, v218
    v_cvt_pk_bf16_f32 v57, v219, v220
    v_cndmask_b32 v56, 0, v56, s[16:17]
    v_cndmask_b32 v57, 0, v57, s[16:17]
    v_lshlrev_b32 v222, 16, v81
    v_sub_f32 v217, v222, v150
    v_sub_f32 v218, v222, v151
    v_sub_f32 v219, v222, v152
    v_sub_f32 v220, v222, v153
    v_cvt_pk_bf16_f32 v221, v217, v218
    v_lshlrev_b32 v217, 16, v221
    v_and_b32 v218, 0xffff0000, v221
    v_cvt_pk_bf16_f32 v221, v219, v220
    v_lshlrev_b32 v219, 16, v221
    v_and_b32 v220, 0xffff0000, v221
    v_mul_f32 v217, v217, v217
    v_mul_f32 v218, v218, v218
    v_mul_f32 v219, v219, v219
    v_mul_f32 v220, v220, v220
    v_cvt_pk_bf16_f32 v221, v217, v218
    v_lshlrev_b32 v217, 16, v221
    v_and_b32 v218, 0xffff0000, v221
    v_cvt_pk_bf16_f32 v221, v219, v220
    v_lshlrev_b32 v219, 16, v221
    v_and_b32 v220, 0xffff0000, v221
    v_mul_f32 v217, 0xc1200000, v217
    v_mul_f32 v218, 0xc1200000, v218
    v_mul_f32 v219, 0xc1200000, v219
    v_mul_f32 v220, 0xc1200000, v220
    v_cvt_pk_bf16_f32 v221, v217, v218
    v_lshlrev_b32 v217, 16, v221
    v_and_b32 v218, 0xffff0000, v221
    v_cvt_pk_bf16_f32 v221, v219, v220
    v_lshlrev_b32 v219, 16, v221
    v_and_b32 v220, 0xffff0000, v221
    v_mul_f32 v217, 0x3fb8aa3b, v217
    v_mul_f32 v218, 0x3fb8aa3b, v218
    v_mul_f32 v219, 0x3fb8aa3b, v219
    v_mul_f32 v220, 0x3fb8aa3b, v220
    v_exp_f32 v217, v217
    v_exp_f32 v218, v218
    v_exp_f32 v219, v219
    v_exp_f32 v220, v220
    v_cvt_pk_bf16_f32 v58, v217, v218
    v_cvt_pk_bf16_f32 v59, v219, v220
    v_cndmask_b32 v58, 0, v58, s[16:17]
    v_cndmask_b32 v59, 0, v59, s[16:17]
    v_lshlrev_b32 v222, 16, v82
    v_sub_f32 v217, v222, v150
    v_sub_f32 v218, v222, v151
    v_sub_f32 v219, v222, v152
    v_sub_f32 v220, v222, v153
    v_cvt_pk_bf16_f32 v221, v217, v218
    v_lshlrev_b32 v217, 16, v221
    v_and_b32 v218, 0xffff0000, v221
    v_cvt_pk_bf16_f32 v221, v219, v220
    v_lshlrev_b32 v219, 16, v221
    v_and_b32 v220, 0xffff0000, v221
    v_mul_f32 v217, v217, v217
    v_mul_f32 v218, v218, v218
    v_mul_f32 v219, v219, v219
    v_mul_f32 v220, v220, v220
    v_cvt_pk_bf16_f32 v221, v217, v218
    v_lshlrev_b32 v217, 16, v221
    v_and_b32 v218, 0xffff0000, v221
    v_cvt_pk_bf16_f32 v221, v219, v220
    v_lshlrev_b32 v219, 16, v221
    v_and_b32 v220, 0xffff0000, v221
    v_mul_f32 v217, 0xc1200000, v217
    v_mul_f32 v218, 0xc1200000, v218
    v_mul_f32 v219, 0xc1200000, v219
    v_mul_f32 v220, 0xc1200000, v220
    v_cvt_pk_bf16_f32 v221, v217, v218
    v_lshlrev_b32 v217, 16, v221
    v_and_b32 v218, 0xffff0000, v221
    v_cvt_pk_bf16_f32 v221, v219, v220
    v_lshlrev_b32 v219, 16, v221
    v_and_b32 v220, 0xffff0000, v221
    v_mul_f32 v217, 0x3fb8aa3b, v217
    v_mul_f32 v218, 0x3fb8aa3b, v218
    v_mul_f32 v219, 0x3fb8aa3b, v219
    v_mul_f32 v220, 0x3fb8aa3b, v220
    v_exp_f32 v217, v217
    v_exp_f32 v218, v218
    v_exp_f32 v219, v219
    v_exp_f32 v220, v220
    v_cvt_pk_bf16_f32 v60, v217, v218
    v_cvt_pk_bf16_f32 v61, v219, v220
    v_cndmask_b32 v60, 0, v60, s[16:17]
    v_cndmask_b32 v61, 0, v61, s[16:17]
    s_not_b64 s[16:17], s[24:25]
    s_waitcnt lgkmcnt(0)
    v_lshl_or_b32 v158, v162, 16, v158
    v_lshl_or_b32 v159, v163, 16, v159
    v_lshl_or_b32 v160, v164, 16, v160
    v_lshl_or_b32 v161, v165, 16, v161
    v_cndmask_b32 v44, 0, v158, s[16:17]
    v_cndmask_b32 v45, 0, v159, s[16:17]
    v_cndmask_b32 v46, 0, v160, s[16:17]
    v_cndmask_b32 v47, 0, v161, s[16:17]
    v_cndmask_b32 v48, 0, v158, s[24:25]
    v_cndmask_b32 v49, 0, v159, s[24:25]
    v_cndmask_b32 v50, 0, v160, s[24:25]
    v_cndmask_b32 v51, 0, v161, s[24:25]
    s_waitcnt vmcnt(6)
    s_lshl_b32 s94, s2, 15
    buffer_load_dwordx4 v[126:129], v73, s[56:59], s94 offen offset:0 sc1
    buffer_load_dwordx4 v[130:133], v73, s[56:59], s94 offen offset:1024 sc1
    buffer_load_dwordx4 v[134:137], v73, s[56:59], s94 offen offset:2048 sc1
    buffer_load_dwordx4 v[138:141], v73, s[56:59], s94 offen offset:3072 sc1
    s_add_u32 s76, s73, 8650752
    buffer_store_dwordx4 v[94:97], v123, s[56:59], s76 offen sc1
    s_add_u32 s76, s73, 8912896
    buffer_store_dwordx4 v[98:101], v123, s[56:59], s76 offen sc1
    s_add_u32 s76, s73, 9175040
    buffer_store_dwordx4 v[102:105], v123, s[56:59], s76 offen sc1
    s_cmp_eq_u64 s[0:1], 0
    s_cbranch_scc1 s2_9
    s_mov_b64 exec, s[0:1]
    s_add_u32 s76, s73, 16777216
    buffer_store_dwordx4 v[106:109], v123, s[56:59], s76 offen sc1
    s_mov_b64 exec, -1
s2_9:
    s_cmp_eq_u64 s[44:45], 0
    s_cbranch_scc1 s2_10
    s_mov_b64 exec, s[44:45]
    s_add_u32 s76, s73, 17039360
    buffer_store_dwordx4 v[110:113], v123, s[56:59], s76 offen sc1
    s_mov_b64 exec, -1
s2_10:
    s_cmp_eq_u64 s[46:47], 0
    s_cbranch_scc1 s2_11
    s_mov_b64 exec, s[46:47]
    s_add_u32 s76, s73, 17301504
    buffer_store_dwordx4 v[114:117], v123, s[56:59], s76 offen sc1
    s_mov_b64 exec, -1
s2_11:
    s_cmp_eq_u64 s[78:79], 0
    s_cbranch_scc1 s2_12
    s_mov_b64 exec, s[78:79]
    s_add_u32 s76, s73, 17563648
    buffer_store_dwordx4 v[118:121], v123, s[56:59], s76 offen sc1
    s_mov_b64 exec, -1
s2_12:
    s_waitcnt vmcnt(6)
    v_perm_b32 v223, v129, v129, v74
    s_nop 1
    v_or_b32_dpp v223, v223, v223 quad_perm:[1,0,3,2] row_mask:0xf bank_mask:0xf
    s_nop 1
    v_or_b32_dpp v223, v223, v223 quad_perm:[2,3,0,1] row_mask:0xf bank_mask:0xf
    v_lshlrev_b32 v224, 8, v223
    v_xad_u32 v223, v223, v224, s68
    v_cmp_le_u32 vcc, 8, v223
    s_cbranch_vccnz c_rp_z0
c_ok_z0:
    v_cmp_gt_u32 s[18:19], s69, v126
    v_cmp_gt_u32 s[20:21], s69, v127
    v_cmp_gt_u32 s[22:23], s69, v128
    v_bfe_u32 v213, v126, 8, 6
    v_bfe_u32 v214, v127, 8, 6
    v_bfe_u32 v215, v128, 8, 6
    v_cmp_le_u32 vcc, s70, v126
    s_nop 1
    v_addc_co_u32 v213, vcc, v213, v213, vcc
    v_cmp_le_u32 vcc, s70, v127
    s_nop 1
    v_addc_co_u32 v214, vcc, v214, v214, vcc
    v_cmp_le_u32 vcc, s70, v128
    s_nop 1
    v_addc_co_u32 v215, vcc, v215, v215, vcc
    v_lshl_add_u32 v216, v213, 2, 64
    v_lshl_add_u32 v217, v214, 2, 64
    v_lshl_add_u32 v218, v215, 2, 64
    s_mov_b64 exec, s[18:19]
    ds_add_rtn_u32 v216, v216, v3
    s_mov_b64 exec, s[20:21]
    ds_add_rtn_u32 v217, v217, v3
    s_mov_b64 exec, s[22:23]
    ds_add_rtn_u32 v218, v218, v3
    s_mov_b64 exec, -1
    v_bfe_u32 v219, v129, 0, 8
    v_bfe_u32 v220, v129, 8, 8
    v_bfe_u32 v221, v129, 16, 8
    v_mad_u32_u24 v213, v213, s71, v75
    v_mad_u32_u24 v214, v214, s71, v75
    v_mad_u32_u24 v215, v215, s71, v75
    s_waitcnt lgkmcnt(0)
    v_min_u32 v216, 192, v216
    v_min_u32 v217, 192, v217
    v_min_u32 v218, 192, v218
    v_lshl_add_u32 v213, v216, 3, v213
    v_lshl_add_u32 v214, v217, 3, v214
    v_lshl_add_u32 v215, v218, 3, v215
    s_mov_b64 exec, s[18:19]
    ds_write2_b32 v213, v126, v219 offset0:0 offset1:1
    s_mov_b64 exec, s[20:21]
    ds_write2_b32 v214, v127, v220 offset0:0 offset1:1
    s_mov_b64 exec, s[22:23]
    ds_write2_b32 v215, v128, v221 offset0:0 offset1:1
    s_mov_b64 exec, -1
    s_waitcnt vmcnt(5)
    v_perm_b32 v223, v133, v133, v74
    s_nop 1
    v_or_b32_dpp v223, v223, v223 quad_perm:[1,0,3,2] row_mask:0xf bank_mask:0xf
    s_nop 1
    v_or_b32_dpp v223, v223, v223 quad_perm:[2,3,0,1] row_mask:0xf bank_mask:0xf
    v_lshlrev_b32 v224, 8, v223
    v_xad_u32 v223, v223, v224, s68
    v_cmp_le_u32 vcc, 8, v223
    s_cbranch_vccnz c_rp_z1
c_ok_z1:
    v_cmp_gt_u32 s[18:19], s69, v130
    v_cmp_gt_u32 s[20:21], s69, v131
    v_cmp_gt_u32 s[22:23], s69, v132
    v_bfe_u32 v213, v130, 8, 6
    v_bfe_u32 v214, v131, 8, 6
    v_bfe_u32 v215, v132, 8, 6
    v_cmp_le_u32 vcc, s70, v130
    s_nop 1
    v_addc_co_u32 v213, vcc, v213, v213, vcc
    v_cmp_le_u32 vcc, s70, v131
    s_nop 1
    v_addc_co_u32 v214, vcc, v214, v214, vcc
    v_cmp_le_u32 vcc, s70, v132
    s_nop 1
    v_addc_co_u32 v215, vcc, v215, v215, vcc
    v_lshl_add_u32 v216, v213, 2, 64
    v_lshl_add_u32 v217, v214, 2, 64
    v_lshl_add_u32 v218, v215, 2, 64
    s_mov_b64 exec, s[18:19]
    ds_add_rtn_u32 v216, v216, v3
    s_mov_b64 exec, s[20:21]
    ds_add_rtn_u32 v217, v217, v3
    s_mov_b64 exec, s[22:23]
    ds_add_rtn_u32 v218, v218, v3
    s_mov_b64 exec, -1
    v_bfe_u32 v219, v133, 0, 8
    v_bfe_u32 v220, v133, 8, 8
    v_bfe_u32 v221, v133, 16, 8
    v_mad_u32_u24 v213, v213, s71, v75
    v_mad_u32_u24 v214, v214, s71, v75
    v_mad_u32_u24 v215, v215, s71, v75
    s_waitcnt lgkmcnt(0)
    v_min_u32 v216, 192, v216
    v_min_u32 v217, 192, v217
    v_min_u32 v218, 192, v218
    v_lshl_add_u32 v213, v216, 3, v213
    v_lshl_add_u32 v214, v217, 3, v214
    v_lshl_add_u32 v215, v218, 3, v215
    s_mov_b64 exec, s[18:19]
    ds_write2_b32 v213, v130, v219 offset0:0 offset1:1
    s_mov_b64 exec, s[20:21]
    ds_write2_b32 v214, v131, v220 offset0:0 offset1:1
    s_mov_b64 exec, s[22:23]
    ds_write2_b32 v215, v132, v221 offset0:0 offset1:1
    s_mov_b64 exec, -1
    s_waitcnt vmcnt(4)
    v_perm_b32 v223, v137, v137, v74
    s_nop 1
    v_or_b32_dpp v223, v223, v223 quad_perm:[1,0,3,2] row_mask:0xf bank_mask:0xf
    s_nop 1
    v_or_b32_dpp v223, v223, v223 quad_perm:[2,3,0,1] row_mask:0xf bank_mask:0xf
    v_lshlrev_b32 v224, 8, v223
    v_xad_u32 v223, v223, v224, s68
    v_cmp_le_u32 vcc, 8, v223
    s_cbranch_vccnz c_rp_z2
c_ok_z2:
    v_cmp_gt_u32 s[18:19], s69, v134
    v_cmp_gt_u32 s[20:21], s69, v135
    v_cmp_gt_u32 s[22:23], s69, v136
    v_bfe_u32 v213, v134, 8, 6
    v_bfe_u32 v214, v135, 8, 6
    v_bfe_u32 v215, v136, 8, 6
    v_cmp_le_u32 vcc, s70, v134
    s_nop 1
    v_addc_co_u32 v213, vcc, v213, v213, vcc
    v_cmp_le_u32 vcc, s70, v135
    s_nop 1
    v_addc_co_u32 v214, vcc, v214, v214, vcc
    v_cmp_le_u32 vcc, s70, v136
    s_nop 1
    v_addc_co_u32 v215, vcc, v215, v215, vcc
    v_lshl_add_u32 v216, v213, 2, 64
    v_lshl_add_u32 v217, v214, 2, 64
    v_lshl_add_u32 v218, v215, 2, 64
    s_mov_b64 exec, s[18:19]
    ds_add_rtn_u32 v216, v216, v3
    s_mov_b64 exec, s[20:21]
    ds_add_rtn_u32 v217, v217, v3
    s_mov_b64 exec, s[22:23]
    ds_add_rtn_u32 v218, v218, v3
    s_mov_b64 exec, -1
    v_bfe_u32 v219, v137, 0, 8
    v_bfe_u32 v220, v137, 8, 8
    v_bfe_u32 v221, v137, 16, 8
    v_mad_u32_u24 v213, v213, s71, v75
    v_mad_u32_u24 v214, v214, s71, v75
    v_mad_u32_u24 v215, v215, s71, v75
    s_waitcnt lgkmcnt(0)
    v_min_u32 v216, 192, v216
    v_min_u32 v217, 192, v217
    v_min_u32 v218, 192, v218
    v_lshl_add_u32 v213, v216, 3, v213
    v_lshl_add_u32 v214, v217, 3, v214
    v_lshl_add_u32 v215, v218, 3, v215
    s_mov_b64 exec, s[18:19]
    ds_write2_b32 v213, v134, v219 offset0:0 offset1:1
    s_mov_b64 exec, s[20:21]
    ds_write2_b32 v214, v135, v220 offset0:0 offset1:1
    s_mov_b64 exec, s[22:23]
    ds_write2_b32 v215, v136, v221 offset0:0 offset1:1
    s_mov_b64 exec, -1
    s_waitcnt vmcnt(3)
    v_perm_b32 v223, v141, v141, v74
    s_nop 1
    v_or_b32_dpp v223, v223, v223 quad_perm:[1,0,3,2] row_mask:0xf bank_mask:0xf
    s_nop 1
    v_or_b32_dpp v223, v223, v223 quad_perm:[2,3,0,1] row_mask:0xf bank_mask:0xf
    v_lshlrev_b32 v224, 8, v223
    v_xad_u32 v223, v223, v224, s68
    v_cmp_le_u32 vcc, 8, v223
    s_cbranch_vccnz c_rp_z3
c_ok_z3:
    v_cmp_gt_u32 s[18:19], s69, v138
    v_cmp_gt_u32 s[20:21], s69, v139
    v_cmp_gt_u32 s[22:23], s69, v140
    v_bfe_u32 v213, v138, 8, 6
    v_bfe_u32 v214, v139, 8, 6
    v_bfe_u32 v215, v140, 8, 6
    v_cmp_le_u32 vcc, s70, v138
    s_nop 1
    v_addc_co_u32 v213, vcc, v213, v213, vcc
    v_cmp_le_u32 vcc, s70, v139
    s_nop 1
    v_addc_co_u32 v214, vcc, v214, v214, vcc
    v_cmp_le_u32 vcc, s70, v140
    s_nop 1
    v_addc_co_u32 v215, vcc, v215, v215, vcc
    v_lshl_add_u32 v216, v213, 2, 64
    v_lshl_add_u32 v217, v214, 2, 64
    v_lshl_add_u32 v218, v215, 2, 64
    s_mov_b64 exec, s[18:19]
    ds_add_rtn_u32 v216, v216, v3
    s_mov_b64 exec, s[20:21]
    ds_add_rtn_u32 v217, v217, v3
    s_mov_b64 exec, s[22:23]
    ds_add_rtn_u32 v218, v218, v3
    s_mov_b64 exec, -1
    v_bfe_u32 v219, v141, 0, 8
    v_bfe_u32 v220, v141, 8, 8
    v_bfe_u32 v221, v141, 16, 8
    v_mad_u32_u24 v213, v213, s71, v75
    v_mad_u32_u24 v214, v214, s71, v75
    v_mad_u32_u24 v215, v215, s71, v75
    s_waitcnt lgkmcnt(0)
    v_min_u32 v216, 192, v216
    v_min_u32 v217, 192, v217
    v_min_u32 v218, 192, v218
    v_lshl_add_u32 v213, v216, 3, v213
    v_lshl_add_u32 v214, v217, 3, v214
    v_lshl_add_u32 v215, v218, 3, v215
    s_mov_b64 exec, s[18:19]
    ds_write2_b32 v213, v138, v219 offset0:0 offset1:1
    s_mov_b64 exec, s[20:21]
    ds_write2_b32 v214, v139, v220 offset0:0 offset1:1
    s_mov_b64 exec, s[22:23]
    ds_write2_b32 v215, v140, v221 offset0:0 offset1:1
    s_mov_b64 exec, -1
    s_cmp_eq_u32 s61, 0
    s_cbranch_scc1 pub_13
    ds_write_b32 v2, v3 offset:16
pub_13:
    s_waitcnt lgkmcnt(0)
    s_barrier
    ds_read_b32 v212, v211 offset:64
    ds_read_b32 v182, v201 offset:0
    ds_read_b32 v183, v201 offset:256
    ds_read_b32 v184, v201 offset:512
    ds_read_b32 v185, v201 offset:768
    ds_read_b64 v[190:191], v203 offset:0
    s_waitcnt lgkmcnt(0)
    v_readlane_b32 s80, v212, 0
    v_readlane_b32 s81, v212, 1
    v_readlane_b32 s82, v212, 2
    v_readlane_b32 s83, v212, 3
    v_readlane_b32 s84, v212, 4
    s_max_u32 s62, s80, s81
    s_max_u32 s63, s82, s83
    s_max_u32 s62, s62, s84
    s_max_u32 s62, s62, s63
    s_cmp_gt_u32 s62, 192
    s_cselect_b32 s62, 1, 0
    s_or_b32 s61, s61, s62
    s_min_u32 s80, s80, 192
    s_min_u32 s81, s81, 192
    s_min_u32 s82, s82, 192
    s_min_u32 s83, s83, 192
    s_min_u32 s84, s84, 192
    v_cmp_gt_u32 vcc, s80, v194
    v_lshrrev_b32 v193, 9, v182
    v_and_or_b32 v193, v193, s92, v200
    v_cndmask_b32 v193, 1.0, v193, vcc
    buffer_load_dwordx4 v[126:129], v193, s[32:35], 0 offen
    v_cmp_gt_u32 vcc, s80, v195
    v_lshrrev_b32 v193, 9, v183
    v_and_or_b32 v193, v193, s92, v200
    v_cndmask_b32 v193, 1.0, v193, vcc
    buffer_load_dwordx4 v[130:133], v193, s[32:35], 0 offen
    v_cmp_gt_u32 vcc, s80, v196
    v_lshrrev_b32 v193, 9, v184
    v_and_or_b32 v193, v193, s92, v200
    v_cndmask_b32 v193, 1.0, v193, vcc
    buffer_load_dwordx4 v[134:137], v193, s[32:35], 0 offen
    v_cmp_gt_u32 vcc, s80, v197
    v_lshrrev_b32 v193, 9, v185
    v_and_or_b32 v193, v193, s92, v200
    v_cndmask_b32 v193, 1.0, v193, vcc
    buffer_load_dwordx4 v[138:141], v193, s[32:35], 0 offen
    v_and_b32 v206, 15, v190
    v_lshl_or_b32 v206, v191, 4, v206
    v_cvt_f32_u32 v206, v206
    v_and_or_b32 v205, v190, s91, v208
    v_fma_f32 v206, v206, s93, v210
    v_fma_f32 v207, v206, v206, -0.5
    v_cndmask_b32 v206, v206, v207, s[24:25]
    v_cvt_pk_bf16_f32 v206, v206, v206
    ds_write_b16 v205, v206
    ds_read_b128 v[174:177], v209
    ds_read_b128 v[178:181], v209 offset:1024
    ds_write_b16 v205, v2
    ds_read_b32 v192, v201 offset:1024
    ds_read_b64 v[190:191], v203 offset:256
    s_mov_b32 s90, 0
c_loop:
    s_waitcnt lgkmcnt(0)
    s_waitcnt vmcnt(3)
    v_mfma_f32_16x16x32_bf16 v[166:169], v[126:129], v[44:47], 0
    v_mfma_f32_16x16x32_bf16 v[170:173], v[126:129], v[48:51], 0
    s_cmp_gt_u32 s80, 128
    s_cbranch_scc0 skg_14
    v_cmp_gt_u32 vcc, s80, v198
    v_lshrrev_b32 v193, 9, v192
    v_and_or_b32 v193, v193, s92, v200
    v_cndmask_b32 v193, 1.0, v193, vcc
    buffer_load_dwordx4 v[142:145], v193, s[32:35], 0 offen
skg_14:
    v_and_b32 v206, 15, v190
    v_lshl_or_b32 v206, v191, 4, v206
    v_cvt_f32_u32 v206, v206
    v_and_or_b32 v205, v190, s91, v208
    v_fma_f32 v206, v206, s93, v210
    v_fma_f32 v207, v206, v206, -0.5
    v_cndmask_b32 v206, v206, v207, s[24:25]
    v_cvt_pk_bf16_f32 v206, v206, v206
    ds_write_b16 v205, v206
    ds_read_b128 v[182:185], v209
    ds_read_b128 v[186:189], v209 offset:1024
    ds_write_b16 v205, v2
    ds_read_b32 v192, v201 offset:1280
    ds_read_b64 v[190:191], v203 offset:512
    v_cvt_pk_bf16_f32 v126, v166, v167
    v_cvt_pk_bf16_f32 v127, v168, v169
    v_cvt_pk_bf16_f32 v128, v170, v171
    v_cvt_pk_bf16_f32 v129, v172, v173
    s_nop 1
    v_mfma_f32_16x16x32_bf16 v[4:7], v[126:129], v[174:177], v[4:7]
    v_mfma_f32_16x16x32_bf16 v[8:11], v[126:129], v[178:181], v[8:11]
    s_waitcnt lgkmcnt(0)
    s_waitcnt vmcnt(2)
    v_mfma_f32_16x16x32_bf16 v[166:169], v[130:133], v[44:47], 0
    v_mfma_f32_16x16x32_bf16 v[170:173], v[130:133], v[48:51], 0
    s_cmp_gt_u32 s80, 160
    s_cbranch_scc0 skg_15
    v_cmp_gt_u32 vcc, s80, v199
    v_lshrrev_b32 v193, 9, v192
    v_and_or_b32 v193, v193, s92, v200
    v_cndmask_b32 v193, 1.0, v193, vcc
    buffer_load_dwordx4 v[146:149], v193, s[32:35], 0 offen
skg_15:
    v_and_b32 v206, 15, v190
    v_lshl_or_b32 v206, v191, 4, v206
    v_cvt_f32_u32 v206, v206
    v_and_or_b32 v205, v190, s91, v208
    v_fma_f32 v206, v206, s93, v210
    v_fma_f32 v207, v206, v206, -0.5
    v_cndmask_b32 v206, v206, v207, s[24:25]
    v_cvt_pk_bf16_f32 v206, v206, v206
    ds_write_b16 v205, v206
    ds_read_b128 v[174:177], v209
    ds_read_b128 v[178:181], v209 offset:1024
    ds_write_b16 v205, v2
    ds_read_b32 v192, v201 offset:3104
    ds_read_b64 v[190:191], v203 offset:768
    v_cvt_pk_bf16_f32 v130, v166, v167
    v_cvt_pk_bf16_f32 v131, v168, v169
    v_cvt_pk_bf16_f32 v132, v170, v171
    v_cvt_pk_bf16_f32 v133, v172, v173
    s_nop 1
    v_mfma_f32_16x16x32_bf16 v[4:7], v[130:133], v[182:185], v[4:7]
    v_mfma_f32_16x16x32_bf16 v[8:11], v[130:133], v[186:189], v[8:11]
    s_cmp_eq_u32 s90, 0
    s_cbranch_scc1 noep_16
    v_lshlrev_b32 v215, 3, v0
    ds_read_b64 v[150:151], v215 offset:1024
    ds_read_b64 v[152:153], v215 offset:1536
    ds_read_b64 v[154:155], v215 offset:2048
    ds_read_b64 v[156:157], v215 offset:2560
noep_16:
    s_waitcnt lgkmcnt(0)
    s_waitcnt vmcnt(1)
    v_mfma_f32_16x16x32_bf16 v[166:169], v[134:137], v[44:47], 0
    v_mfma_f32_16x16x32_bf16 v[170:173], v[134:137], v[48:51], 0
    v_cmp_gt_u32 vcc, s81, v194
    v_lshrrev_b32 v193, 9, v192
    v_and_or_b32 v193, v193, s92, v200
    v_cndmask_b32 v193, 1.0, v193, vcc
    buffer_load_dwordx4 v[126:129], v193, s[32:35], 0 offen
    v_and_b32 v206, 15, v190
    v_lshl_or_b32 v206, v191, 4, v206
    v_cvt_f32_u32 v206, v206
    v_and_or_b32 v205, v190, s91, v208
    v_fma_f32 v206, v206, s93, v210
    v_fma_f32 v207, v206, v206, -0.5
    v_cndmask_b32 v206, v206, v207, s[24:25]
    v_cvt_pk_bf16_f32 v206, v206, v206
    ds_write_b16 v205, v206
    ds_read_b128 v[182:185], v209
    ds_read_b128 v[186:189], v209 offset:1024
    ds_write_b16 v205, v2
    ds_read_b32 v192, v201 offset:3360
    ds_read_b64 v[190:191], v203 offset:1024
    v_cvt_pk_bf16_f32 v134, v166, v167
    v_cvt_pk_bf16_f32 v135, v168, v169
    v_cvt_pk_bf16_f32 v136, v170, v171
    v_cvt_pk_bf16_f32 v137, v172, v173
    s_nop 1
    v_mfma_f32_16x16x32_bf16 v[4:7], v[134:137], v[174:177], v[4:7]
    v_mfma_f32_16x16x32_bf16 v[8:11], v[134:137], v[178:181], v[8:11]
    s_cmp_eq_u32 s90, 0
    s_cbranch_scc0 nost_17
    s_add_u32 s62, s94, 8388608
    buffer_load_dwordx4 v[150:153], v73, s[56:59], s62 offen offset:0 sc1
nost_17:
    s_waitcnt lgkmcnt(0)
    s_waitcnt vmcnt(1)
    v_mfma_f32_16x16x32_bf16 v[166:169], v[138:141], v[44:47], 0
    v_mfma_f32_16x16x32_bf16 v[170:173], v[138:141], v[48:51], 0
    v_cmp_gt_u32 vcc, s81, v195
    v_lshrrev_b32 v193, 9, v192
    v_and_or_b32 v193, v193, s92, v200
    v_cndmask_b32 v193, 1.0, v193, vcc
    buffer_load_dwordx4 v[130:133], v193, s[32:35], 0 offen
    s_cmp_gt_u32 s80, 128
    s_cbranch_scc0 sk2_18
    v_and_b32 v206, 15, v190
    v_lshl_or_b32 v206, v191, 4, v206
    v_cvt_f32_u32 v206, v206
    v_and_or_b32 v205, v190, s91, v208
    v_fma_f32 v206, v206, s93, v210
    v_fma_f32 v207, v206, v206, -0.5
    v_cndmask_b32 v206, v206, v207, s[24:25]
    v_cvt_pk_bf16_f32 v206, v206, v206
    ds_write_b16 v205, v206
    ds_read_b128 v[174:177], v209
    ds_read_b128 v[178:181], v209 offset:1024
    ds_write_b16 v205, v2
sk2_18:
    ds_read_b32 v192, v201 offset:3616
    ds_read_b64 v[190:191], v203 offset:1280
    v_cvt_pk_bf16_f32 v138, v166, v167
    v_cvt_pk_bf16_f32 v139, v168, v169
    v_cvt_pk_bf16_f32 v140, v170, v171
    v_cvt_pk_bf16_f32 v141, v172, v173
    s_nop 1
    v_mfma_f32_16x16x32_bf16 v[4:7], v[138:141], v[182:185], v[4:7]
    v_mfma_f32_16x16x32_bf16 v[8:11], v[138:141], v[186:189], v[8:11]
    s_cmp_eq_u32 s90, 0
    s_cbranch_scc0 nost_19
    s_add_u32 s62, s94, 8388608
    buffer_load_dwordx4 v[154:157], v73, s[56:59], s62 offen offset:1024 sc1
nost_19:
    s_waitcnt lgkmcnt(0)
    s_cmp_gt_u32 s80, 128
    s_cbranch_scc0 sk1_20
    s_waitcnt vmcnt(2)
    v_mfma_f32_16x16x32_bf16 v[166:169], v[142:145], v[44:47], 0
    v_mfma_f32_16x16x32_bf16 v[170:173], v[142:145], v[48:51], 0
sk1_20:
    v_cmp_gt_u32 vcc, s81, v196
    v_lshrrev_b32 v193, 9, v192
    v_and_or_b32 v193, v193, s92, v200
    v_cndmask_b32 v193, 1.0, v193, vcc
    buffer_load_dwordx4 v[134:137], v193, s[32:35], 0 offen
    s_cmp_gt_u32 s80, 160
    s_cbranch_scc0 sk2_21
    v_and_b32 v206, 15, v190
    v_lshl_or_b32 v206, v191, 4, v206
    v_cvt_f32_u32 v206, v206
    v_and_or_b32 v205, v190, s91, v208
    v_fma_f32 v206, v206, s93, v210
    v_fma_f32 v207, v206, v206, -0.5
    v_cndmask_b32 v206, v206, v207, s[24:25]
    v_cvt_pk_bf16_f32 v206, v206, v206
    ds_write_b16 v205, v206
    ds_read_b128 v[182:185], v209
    ds_read_b128 v[186:189], v209 offset:1024
    ds_write_b16 v205, v2
sk2_21:
    ds_read_b32 v192, v201 offset:3872
    ds_read_b64 v[190:191], v203 offset:3104
    s_cmp_gt_u32 s80, 128
    s_cbranch_scc0 sk3_22
    v_cvt_pk_bf16_f32 v142, v166, v167
    v_cvt_pk_bf16_f32 v143, v168, v169
    v_cvt_pk_bf16_f32 v144, v170, v171
    v_cvt_pk_bf16_f32 v145, v172, v173
    s_nop 1
    v_mfma_f32_16x16x32_bf16 v[4:7], v[142:145], v[174:177], v[4:7]
    v_mfma_f32_16x16x32_bf16 v[8:11], v[142:145], v[178:181], v[8:11]
sk3_22:
    s_cmp_eq_u32 s90, 0
    s_cbranch_scc0 nost_23
    s_add_u32 s62, s94, 8388608
    buffer_load_dwordx4 v[158:161], v73, s[56:59], s62 offen offset:2048 sc1
nost_23:
    s_waitcnt lgkmcnt(0)
    s_cmp_gt_u32 s80, 160
    s_cbranch_scc0 sk1_24
    s_waitcnt vmcnt(3)
    v_mfma_f32_16x16x32_bf16 v[166:169], v[146:149], v[44:47], 0
    v_mfma_f32_16x16x32_bf16 v[170:173], v[146:149], v[48:51], 0
sk1_24:
    v_cmp_gt_u32 vcc, s81, v197
    v_lshrrev_b32 v193, 9, v192
    v_and_or_b32 v193, v193, s92, v200
    v_cndmask_b32 v193, 1.0, v193, vcc
    buffer_load_dwordx4 v[138:141], v193, s[32:35], 0 offen
    v_and_b32 v206, 15, v190
    v_lshl_or_b32 v206, v191, 4, v206
    v_cvt_f32_u32 v206, v206
    v_and_or_b32 v205, v190, s91, v208
    v_fma_f32 v206, v206, s93, v210
    v_fma_f32 v207, v206, v206, -0.5
    v_cndmask_b32 v206, v206, v207, s[24:25]
    v_cvt_pk_bf16_f32 v206, v206, v206
    ds_write_b16 v205, v206
    ds_read_b128 v[174:177], v209
    ds_read_b128 v[178:181], v209 offset:1024
    ds_write_b16 v205, v2
    ds_read_b32 v192, v201 offset:4128
    ds_read_b64 v[190:191], v203 offset:3360
    s_cmp_gt_u32 s80, 160
    s_cbranch_scc0 sk3_25
    v_cvt_pk_bf16_f32 v146, v166, v167
    v_cvt_pk_bf16_f32 v147, v168, v169
    v_cvt_pk_bf16_f32 v148, v170, v171
    v_cvt_pk_bf16_f32 v149, v172, v173
    s_nop 1
    v_mfma_f32_16x16x32_bf16 v[4:7], v[146:149], v[182:185], v[4:7]
    v_mfma_f32_16x16x32_bf16 v[8:11], v[146:149], v[186:189], v[8:11]
sk3_25:
    s_cmp_eq_u32 s90, 0
    s_cbranch_scc0 nost_26
    s_add_u32 s62, s94, 8388608
    buffer_load_dwordx4 v[162:165], v73, s[56:59], s62 offen offset:3072 sc1
nost_26:
    s_waitcnt lgkmcnt(0)
    s_waitcnt vmcnt(3)
    v_mfma_f32_16x16x32_bf16 v[166:169], v[126:129], v[44:47], 0
    v_mfma_f32_16x16x32_bf16 v[170:173], v[126:129], v[48:51], 0
    s_cmp_gt_u32 s81, 128
    s_cbranch_scc0 skg_27
    v_cmp_gt_u32 vcc, s81, v198
    v_lshrrev_b32 v193, 9, v192
    v_and_or_b32 v193, v193, s92, v200
    v_cndmask_b32 v193, 1.0, v193, vcc
    buffer_load_dwordx4 v[142:145], v193, s[32:35], 0 offen
skg_27:
    v_and_b32 v206, 15, v190
    v_lshl_or_b32 v206, v191, 4, v206
    v_cvt_f32_u32 v206, v206
    v_and_or_b32 v205, v190, s91, v208
    v_fma_f32 v206, v206, s93, v210
    v_fma_f32 v207, v206, v206, -0.5
    v_cndmask_b32 v206, v206, v207, s[24:25]
    v_cvt_pk_bf16_f32 v206, v206, v206
    ds_write_b16 v205, v206
    ds_read_b128 v[182:185], v209
    ds_read_b128 v[186:189], v209 offset:1024
    ds_write_b16 v205, v2
    ds_read_b32 v192, v201 offset:4384
    ds_read_b64 v[190:191], v203 offset:3616
    v_cvt_pk_bf16_f32 v126, v166, v167
    v_cvt_pk_bf16_f32 v127, v168, v169
    v_cvt_pk_bf16_f32 v128, v170, v171
    v_cvt_pk_bf16_f32 v129, v172, v173
    s_nop 1
    v_mfma_f32_16x16x32_bf16 v[12:15], v[126:129], v[174:177], v[12:15]
    v_mfma_f32_16x16x32_bf16 v[16:19], v[126:129], v[178:181], v[16:19]
    s_cmp_eq_u32 s90, 0
    s_cbranch_scc1 noep_28
    v_mfma_f32_16x16x16_bf16 v[158:161], v[150:151], v[52:53], 0
    v_mfma_f32_16x16x16_bf16 v[162:165], v[152:153], v[52:53], 0
    v_mfma_f32_16x16x16_bf16 v[226:229], v[154:155], v[52:53], 0
    v_lshlrev_b32 v234, 16, v62
    v_and_b32 v235, 0xffff0000, v62
    v_lshlrev_b32 v236, 16, v63
    v_and_b32 v237, 0xffff0000, v63
    s_nop 1
    v_mul_f32 v158, v158, v4
    v_mul_f32 v159, v159, v5
    v_mul_f32 v160, v160, v6
    v_mul_f32 v161, v161, v7
    v_fma_f32 v158, v162, v8, v158
    v_fma_f32 v159, v163, v9, v159
    v_fma_f32 v160, v164, v10, v160
    v_fma_f32 v161, v165, v11, v161
    v_cvt_pk_bf16_f32 v238, v158, v159
    v_cvt_pk_bf16_f32 v239, v160, v161
    s_nop 1
    v_mfma_f32_16x16x16_bf16 v[230:233], v[156:157], v[238:239], 0
    s_nop 7
    v_fma_f32 v234, v230, v226, v234
    v_fma_f32 v235, v231, v227, v235
    v_fma_f32 v236, v232, v228, v236
    v_fma_f32 v237, v233, v229, v237
    v_cvt_pk_bf16_f32 v62, v234, v235
    v_cvt_pk_bf16_f32 v63, v236, v237
noep_28:
    s_waitcnt lgkmcnt(0)
    s_waitcnt vmcnt(2)
    v_mfma_f32_16x16x32_bf16 v[166:169], v[130:133], v[44:47], 0
    v_mfma_f32_16x16x32_bf16 v[170:173], v[130:133], v[48:51], 0
    s_cmp_gt_u32 s81, 160
    s_cbranch_scc0 skg_29
    v_cmp_gt_u32 vcc, s81, v199
    v_lshrrev_b32 v193, 9, v192
    v_and_or_b32 v193, v193, s92, v200
    v_cndmask_b32 v193, 1.0, v193, vcc
    buffer_load_dwordx4 v[146:149], v193, s[32:35], 0 offen
skg_29:
    v_and_b32 v206, 15, v190
    v_lshl_or_b32 v206, v191, 4, v206
    v_cvt_f32_u32 v206, v206
    v_and_or_b32 v205, v190, s91, v208
    v_fma_f32 v206, v206, s93, v210
    v_fma_f32 v207, v206, v206, -0.5
    v_cndmask_b32 v206, v206, v207, s[24:25]
    v_cvt_pk_bf16_f32 v206, v206, v206
    ds_write_b16 v205, v206
    ds_read_b128 v[174:177], v209
    ds_read_b128 v[178:181], v209 offset:1024
    ds_write_b16 v205, v2
    ds_read_b32 v192, v201 offset:6208
    ds_read_b64 v[190:191], v203 offset:3872
    v_cvt_pk_bf16_f32 v130, v166, v167
    v_cvt_pk_bf16_f32 v131, v168, v169
    v_cvt_pk_bf16_f32 v132, v170, v171
    v_cvt_pk_bf16_f32 v133, v172, v173
    s_nop 1
    v_mfma_f32_16x16x32_bf16 v[12:15], v[130:133], v[182:185], v[12:15]
    v_mfma_f32_16x16x32_bf16 v[16:19], v[130:133], v[186:189], v[16:19]
    s_waitcnt lgkmcnt(0)
    s_waitcnt vmcnt(1)
    v_mfma_f32_16x16x32_bf16 v[166:169], v[134:137], v[44:47], 0
    v_mfma_f32_16x16x32_bf16 v[170:173], v[134:137], v[48:51], 0
    v_cmp_gt_u32 vcc, s82, v194
    v_lshrrev_b32 v193, 9, v192
    v_and_or_b32 v193, v193, s92, v200
    v_cndmask_b32 v193, 1.0, v193, vcc
    buffer_load_dwordx4 v[126:129], v193, s[32:35], 0 offen
    v_and_b32 v206, 15, v190
    v_lshl_or_b32 v206, v191, 4, v206
    v_cvt_f32_u32 v206, v206
    v_and_or_b32 v205, v190, s91, v208
    v_fma_f32 v206, v206, s93, v210
    v_fma_f32 v207, v206, v206, -0.5
    v_cndmask_b32 v206, v206, v207, s[24:25]
    v_cvt_pk_bf16_f32 v206, v206, v206
    ds_write_b16 v205, v206
    ds_read_b128 v[182:185], v209
    ds_read_b128 v[186:189], v209 offset:1024
    ds_write_b16 v205, v2
    ds_read_b32 v192, v201 offset:6464
    ds_read_b64 v[190:191], v203 offset:4128
    v_cvt_pk_bf16_f32 v134, v166, v167
    v_cvt_pk_bf16_f32 v135, v168, v169
    v_cvt_pk_bf16_f32 v136, v170, v171
    v_cvt_pk_bf16_f32 v137, v172, v173
    s_nop 1
    v_mfma_f32_16x16x32_bf16 v[12:15], v[134:137], v[174:177], v[12:15]
    v_mfma_f32_16x16x32_bf16 v[16:19], v[134:137], v[178:181], v[16:19]
    s_cmp_eq_u32 s90, 0
    s_cbranch_scc0 noins_30
    s_waitcnt vmcnt(4)
    v_perm_b32 v223, v153, v153, v74
    s_nop 1
    v_or_b32_dpp v223, v223, v223 quad_perm:[1,0,3,2] row_mask:0xf bank_mask:0xf
    s_nop 1
    v_or_b32_dpp v223, v223, v223 quad_perm:[2,3,0,1] row_mask:0xf bank_mask:0xf
    v_lshlrev_b32 v224, 8, v223
    v_xad_u32 v223, v223, v224, s68
    v_cmp_le_u32 vcc, 8, v223
    s_cbranch_vccnz c_rp_p0
c_ok_p0:
    v_cmp_gt_u32 s[18:19], s69, v150
    v_cmp_gt_u32 s[20:21], s69, v151
    v_cmp_gt_u32 s[22:23], s69, v152
    v_bfe_u32 v213, v150, 8, 6
    v_bfe_u32 v214, v151, 8, 6
    v_bfe_u32 v215, v152, 8, 6
    v_lshl_or_b32 v213, v213, 1, 1
    v_lshl_or_b32 v214, v214, 1, 1
    v_lshl_or_b32 v215, v215, 1, 1
    s_andn2_b64 s[22:23], s[22:23], s[26:27]
    s_mov_b32 s62, 12845056
    s_mov_b32 s63, 19136512
    v_cmp_le_u32 vcc, s62, v152
    v_cmp_le_u32 s[16:17], s63, v152
    v_lshl_add_u32 v216, v213, 2, 64
    v_lshl_add_u32 v217, v214, 2, 64
    v_lshl_add_u32 v218, v215, 2, 64
    s_mov_b64 exec, s[18:19]
    ds_add_rtn_u32 v216, v216, v3
    s_mov_b64 exec, s[20:21]
    ds_add_rtn_u32 v217, v217, v3
    s_mov_b64 exec, s[22:23]
    ds_add_rtn_u32 v218, v218, v3
    s_mov_b64 exec, -1
    v_bfe_u32 v219, v153, 0, 8
    v_bfe_u32 v220, v153, 8, 8
    v_bfe_u32 v221, v153, 16, 8
    v_mad_u32_u24 v213, v213, s71, v75
    v_mad_u32_u24 v214, v214, s71, v75
    v_mad_u32_u24 v215, v215, s71, v75
    s_and_b64 s[4:5], vcc, s[26:27]
    s_lshr_b64 s[4:5], s[4:5], 7
    s_lshl_b64 s[12:13], s[4:5], 8
    s_sub_u32 s4, s12, s4
    s_subb_u32 s5, s13, s5
    s_waitcnt lgkmcnt(0)
    v_min_u32 v216, 192, v216
    v_min_u32 v217, 192, v217
    v_min_u32 v218, 192, v218
    v_lshl_add_u32 v213, v216, 3, v213
    v_lshl_add_u32 v214, v217, 3, v214
    v_lshl_add_u32 v215, v218, 3, v215
    s_mov_b64 exec, s[18:19]
    ds_write2_b32 v213, v150, v219 offset0:0 offset1:1
    s_mov_b64 exec, s[20:21]
    ds_write2_b32 v214, v151, v220 offset0:0 offset1:1
    s_mov_b64 exec, s[22:23]
    ds_write2_b32 v215, v152, v221 offset0:0 offset1:1
    s_mov_b64 exec, -1
    s_and_b64 s[16:17], s[16:17], s[26:27]
    s_cbranch_scc1 c_l3_0
c_l3_back_0:
    s_cmp_eq_u64 s[4:5], 0
    s_cbranch_scc1 sl_31
    s_add_u32 s62, s94, 16777216
    s_mov_b64 exec, s[4:5]
    buffer_load_dwordx4 v[150:153], v73, s[56:59], s62 offen offset:0 sc1
    s_mov_b64 exec, -1
sl_31:
noins_30:
    s_waitcnt lgkmcnt(0)
    s_waitcnt vmcnt(1)
    v_mfma_f32_16x16x32_bf16 v[166:169], v[138:141], v[44:47], 0
    v_mfma_f32_16x16x32_bf16 v[170:173], v[138:141], v[48:51], 0
    v_cmp_gt_u32 vcc, s82, v195
    v_lshrrev_b32 v193, 9, v192
    v_and_or_b32 v193, v193, s92, v200
    v_cndmask_b32 v193, 1.0, v193, vcc
    buffer_load_dwordx4 v[130:133], v193, s[32:35], 0 offen
    s_cmp_gt_u32 s81, 128
    s_cbranch_scc0 sk2_32
    v_and_b32 v206, 15, v190
    v_lshl_or_b32 v206, v191, 4, v206
    v_cvt_f32_u32 v206, v206
    v_and_or_b32 v205, v190, s91, v208
    v_fma_f32 v206, v206, s93, v210
    v_fma_f32 v207, v206, v206, -0.5
    v_cndmask_b32 v206, v206, v207, s[24:25]
    v_cvt_pk_bf16_f32 v206, v206, v206
    ds_write_b16 v205, v206
    ds_read_b128 v[174:177], v209
    ds_read_b128 v[178:181], v209 offset:1024
    ds_write_b16 v205, v2
sk2_32:
    ds_read_b32 v192, v201 offset:6720
    ds_read_b64 v[190:191], v203 offset:4384
    v_cvt_pk_bf16_f32 v138, v166, v167
    v_cvt_pk_bf16_f32 v139, v168, v169
    v_cvt_pk_bf16_f32 v140, v170, v171
    v_cvt_pk_bf16_f32 v141, v172, v173
    s_nop 1
    v_mfma_f32_16x16x32_bf16 v[12:15], v[138:141], v[182:185], v[12:15]
    v_mfma_f32_16x16x32_bf16 v[16:19], v[138:141], v[186:189], v[16:19]
    s_cmp_eq_u32 s90, 0
    s_cbranch_scc0 noins_33
    s_waitcnt vmcnt(4)
    v_perm_b32 v223, v157, v157, v74
    s_nop 1
    v_or_b32_dpp v223, v223, v223 quad_perm:[1,0,3,2] row_mask:0xf bank_mask:0xf
    s_nop 1
    v_or_b32_dpp v223, v223, v223 quad_perm:[2,3,0,1] row_mask:0xf bank_mask:0xf
    v_lshlrev_b32 v224, 8, v223
    v_xad_u32 v223, v223, v224, s68
    v_cmp_le_u32 vcc, 8, v223
    s_cbranch_vccnz c_rp_p1
c_ok_p1:
    v_cmp_gt_u32 s[18:19], s69, v154
    v_cmp_gt_u32 s[20:21], s69, v155
    v_cmp_gt_u32 s[22:23], s69, v156
    v_bfe_u32 v213, v154, 8, 6
    v_bfe_u32 v214, v155, 8, 6
    v_bfe_u32 v215, v156, 8, 6
    v_lshl_or_b32 v213, v213, 1, 1
    v_lshl_or_b32 v214, v214, 1, 1
    v_lshl_or_b32 v215, v215, 1, 1
    s_andn2_b64 s[22:23], s[22:23], s[26:27]
    s_mov_b32 s62, 12845056
    s_mov_b32 s63, 19136512
    v_cmp_le_u32 vcc, s62, v156
    v_cmp_le_u32 s[16:17], s63, v156
    v_lshl_add_u32 v216, v213, 2, 64
    v_lshl_add_u32 v217, v214, 2, 64
    v_lshl_add_u32 v218, v215, 2, 64
    s_mov_b64 exec, s[18:19]
    ds_add_rtn_u32 v216, v216, v3
    s_mov_b64 exec, s[20:21]
    ds_add_rtn_u32 v217, v217, v3
    s_mov_b64 exec, s[22:23]
    ds_add_rtn_u32 v218, v218, v3
    s_mov_b64 exec, -1
    v_bfe_u32 v219, v157, 0, 8
    v_bfe_u32 v220, v157, 8, 8
    v_bfe_u32 v221, v157, 16, 8
    v_mad_u32_u24 v213, v213, s71, v75
    v_mad_u32_u24 v214, v214, s71, v75
    v_mad_u32_u24 v215, v215, s71, v75
    s_and_b64 s[6:7], vcc, s[26:27]
    s_lshr_b64 s[6:7], s[6:7], 7
    s_lshl_b64 s[12:13], s[6:7], 8
    s_sub_u32 s6, s12, s6
    s_subb_u32 s7, s13, s7
    s_waitcnt lgkmcnt(0)
    v_min_u32 v216, 192, v216
    v_min_u32 v217, 192, v217
    v_min_u32 v218, 192, v218
    v_lshl_add_u32 v213, v216, 3, v213
    v_lshl_add_u32 v214, v217, 3, v214
    v_lshl_add_u32 v215, v218, 3, v215
    s_mov_b64 exec, s[18:19]
    ds_write2_b32 v213, v154, v219 offset0:0 offset1:1
    s_mov_b64 exec, s[20:21]
    ds_write2_b32 v214, v155, v220 offset0:0 offset1:1
    s_mov_b64 exec, s[22:23]
    ds_write2_b32 v215, v156, v221 offset0:0 offset1:1
    s_mov_b64 exec, -1
    s_and_b64 s[16:17], s[16:17], s[26:27]
    s_cbranch_scc1 c_l3_1
c_l3_back_1:
    s_cmp_eq_u64 s[6:7], 0
    s_cbranch_scc1 sl_34
    s_add_u32 s62, s94, 16777216
    s_mov_b64 exec, s[6:7]
    buffer_load_dwordx4 v[154:157], v73, s[56:59], s62 offen offset:1024 sc1
    s_mov_b64 exec, -1
sl_34:
noins_33:
    s_waitcnt lgkmcnt(0)
    s_cmp_gt_u32 s81, 128
    s_cbranch_scc0 sk1_35
    s_waitcnt vmcnt(2)
    v_mfma_f32_16x16x32_bf16 v[166:169], v[142:145], v[44:47], 0
    v_mfma_f32_16x16x32_bf16 v[170:173], v[142:145], v[48:51], 0
sk1_35:
    v_cmp_gt_u32 vcc, s82, v196
    v_lshrrev_b32 v193, 9, v192
    v_and_or_b32 v193, v193, s92, v200
    v_cndmask_b32 v193, 1.0, v193, vcc
    buffer_load_dwordx4 v[134:137], v193, s[32:35], 0 offen
    s_cmp_gt_u32 s81, 160
    s_cbranch_scc0 sk2_36
    v_and_b32 v206, 15, v190
    v_lshl_or_b32 v206, v191, 4, v206
    v_cvt_f32_u32 v206, v206
    v_and_or_b32 v205, v190, s91, v208
    v_fma_f32 v206, v206, s93, v210
    v_fma_f32 v207, v206, v206, -0.5
    v_cndmask_b32 v206, v206, v207, s[24:25]
    v_cvt_pk_bf16_f32 v206, v206, v206
    ds_write_b16 v205, v206
    ds_read_b128 v[182:185], v209
    ds_read_b128 v[186:189], v209 offset:1024
    ds_write_b16 v205, v2
sk2_36:
    ds_read_b32 v192, v201 offset:6976
    ds_read_b64 v[190:191], v203 offset:6208
    s_cmp_gt_u32 s81, 128
    s_cbranch_scc0 sk3_37
    v_cvt_pk_bf16_f32 v142, v166, v167
    v_cvt_pk_bf16_f32 v143, v168, v169
    v_cvt_pk_bf16_f32 v144, v170, v171
    v_cvt_pk_bf16_f32 v145, v172, v173
    s_nop 1
    v_mfma_f32_16x16x32_bf16 v[12:15], v[142:145], v[174:177], v[12:15]
    v_mfma_f32_16x16x32_bf16 v[16:19], v[142:145], v[178:181], v[16:19]
sk3_37:
    s_cmp_eq_u32 s90, 0
    s_cbranch_scc0 noins_38
    s_waitcnt vmcnt(4)
    v_perm_b32 v223, v161, v161, v74
    s_nop 1
    v_or_b32_dpp v223, v223, v223 quad_perm:[1,0,3,2] row_mask:0xf bank_mask:0xf
    s_nop 1
    v_or_b32_dpp v223, v223, v223 quad_perm:[2,3,0,1] row_mask:0xf bank_mask:0xf
    v_lshlrev_b32 v224, 8, v223
    v_xad_u32 v223, v223, v224, s68
    v_cmp_le_u32 vcc, 8, v223
    s_cbranch_vccnz c_rp_p2
c_ok_p2:
    v_cmp_gt_u32 s[18:19], s69, v158
    v_cmp_gt_u32 s[20:21], s69, v159
    v_cmp_gt_u32 s[22:23], s69, v160
    v_bfe_u32 v213, v158, 8, 6
    v_bfe_u32 v214, v159, 8, 6
    v_bfe_u32 v215, v160, 8, 6
    v_lshl_or_b32 v213, v213, 1, 1
    v_lshl_or_b32 v214, v214, 1, 1
    v_lshl_or_b32 v215, v215, 1, 1
    s_andn2_b64 s[22:23], s[22:23], s[26:27]
    s_mov_b32 s62, 12845056
    s_mov_b32 s63, 19136512
    v_cmp_le_u32 vcc, s62, v160
    v_cmp_le_u32 s[16:17], s63, v160
    v_lshl_add_u32 v216, v213, 2, 64
    v_lshl_add_u32 v217, v214, 2, 64
    v_lshl_add_u32 v218, v215, 2, 64
    s_mov_b64 exec, s[18:19]
    ds_add_rtn_u32 v216, v216, v3
    s_mov_b64 exec, s[20:21]
    ds_add_rtn_u32 v217, v217, v3
    s_mov_b64 exec, s[22:23]
    ds_add_rtn_u32 v218, v218, v3
    s_mov_b64 exec, -1
    v_bfe_u32 v219, v161, 0, 8
    v_bfe_u32 v220, v161, 8, 8
    v_bfe_u32 v221, v161, 16, 8
    v_mad_u32_u24 v213, v213, s71, v75
    v_mad_u32_u24 v214, v214, s71, v75
    v_mad_u32_u24 v215, v215, s71, v75
    s_and_b64 s[8:9], vcc, s[26:27]
    s_lshr_b64 s[8:9], s[8:9], 7
    s_lshl_b64 s[12:13], s[8:9], 8
    s_sub_u32 s8, s12, s8
    s_subb_u32 s9, s13, s9
    s_waitcnt lgkmcnt(0)
    v_min_u32 v216, 192, v216
    v_min_u32 v217, 192, v217
    v_min_u32 v218, 192, v218
    v_lshl_add_u32 v213, v216, 3, v213
    v_lshl_add_u32 v214, v217, 3, v214
    v_lshl_add_u32 v215, v218, 3, v215
    s_mov_b64 exec, s[18:19]
    ds_write2_b32 v213, v158, v219 offset0:0 offset1:1
    s_mov_b64 exec, s[20:21]
    ds_write2_b32 v214, v159, v220 offset0:0 offset1:1
    s_mov_b64 exec, s[22:23]
    ds_write2_b32 v215, v160, v221 offset0:0 offset1:1
    s_mov_b64 exec, -1
    s_and_b64 s[16:17], s[16:17], s[26:27]
    s_cbranch_scc1 c_l3_2
c_l3_back_2:
    s_cmp_eq_u64 s[8:9], 0
    s_cbranch_scc1 sl_39
    s_add_u32 s62, s94, 16777216
    s_mov_b64 exec, s[8:9]
    buffer_load_dwordx4 v[158:161], v73, s[56:59], s62 offen offset:2048 sc1
    s_mov_b64 exec, -1
sl_39:
noins_38:
    s_waitcnt lgkmcnt(0)
    s_cmp_gt_u32 s81, 160
    s_cbranch_scc0 sk1_40
    s_waitcnt vmcnt(3)
    v_mfma_f32_16x16x32_bf16 v[166:169], v[146:149], v[44:47], 0
    v_mfma_f32_16x16x32_bf16 v[170:173], v[146:149], v[48:51], 0
sk1_40:
    v_cmp_gt_u32 vcc, s82, v197
    v_lshrrev_b32 v193, 9, v192
    v_and_or_b32 v193, v193, s92, v200
    v_cndmask_b32 v193, 1.0, v193, vcc
    buffer_load_dwordx4 v[138:141], v193, s[32:35], 0 offen
    v_and_b32 v206, 15, v190
    v_lshl_or_b32 v206, v191, 4, v206
    v_cvt_f32_u32 v206, v206
    v_and_or_b32 v205, v190, s91, v208
    v_fma_f32 v206, v206, s93, v210
    v_fma_f32 v207, v206, v206, -0.5
    v_cndmask_b32 v206, v206, v207, s[24:25]
    v_cvt_pk_bf16_f32 v206, v206, v206
    ds_write_b16 v205, v206
    ds_read_b128 v[174:177], v209
    ds_read_b128 v[178:181], v209 offset:1024
    ds_write_b16 v205, v2
    ds_read_b32 v192, v201 offset:7232
    ds_read_b64 v[190:191], v203 offset:6464
    s_cmp_gt_u32 s81, 160
    s_cbranch_scc0 sk3_41
    v_cvt_pk_bf16_f32 v146, v166, v167
    v_cvt_pk_bf16_f32 v147, v168, v169
    v_cvt_pk_bf16_f32 v148, v170, v171
    v_cvt_pk_bf16_f32 v149, v172, v173
    s_nop 1
    v_mfma_f32_16x16x32_bf16 v[12:15], v[146:149], v[182:185], v[12:15]
    v_mfma_f32_16x16x32_bf16 v[16:19], v[146:149], v[186:189], v[16:19]
sk3_41:
    s_cmp_eq_u32 s90, 0
    s_cbranch_scc0 noins_42
    s_waitcnt vmcnt(4)
    v_perm_b32 v223, v165, v165, v74
    s_nop 1
    v_or_b32_dpp v223, v223, v223 quad_perm:[1,0,3,2] row_mask:0xf bank_mask:0xf
    s_nop 1
    v_or_b32_dpp v223, v223, v223 quad_perm:[2,3,0,1] row_mask:0xf bank_mask:0xf
    v_lshlrev_b32 v224, 8, v223
    v_xad_u32 v223, v223, v224, s68
    v_cmp_le_u32 vcc, 8, v223
    s_cbranch_vccnz c_rp_p3
c_ok_p3:
    v_cmp_gt_u32 s[18:19], s69, v162
    v_cmp_gt_u32 s[20:21], s69, v163
    v_cmp_gt_u32 s[22:23], s69, v164
    v_bfe_u32 v213, v162, 8, 6
    v_bfe_u32 v214, v163, 8, 6
    v_bfe_u32 v215, v164, 8, 6
    v_lshl_or_b32 v213, v213, 1, 1
    v_lshl_or_b32 v214, v214, 1, 1
    v_lshl_or_b32 v215, v215, 1, 1
    s_andn2_b64 s[22:23], s[22:23], s[26:27]
    s_mov_b32 s62, 12845056
    s_mov_b32 s63, 19136512
    v_cmp_le_u32 vcc, s62, v164
    v_cmp_le_u32 s[16:17], s63, v164
    v_lshl_add_u32 v216, v213, 2, 64
    v_lshl_add_u32 v217, v214, 2, 64
    v_lshl_add_u32 v218, v215, 2, 64
    s_mov_b64 exec, s[18:19]
    ds_add_rtn_u32 v216, v216, v3
    s_mov_b64 exec, s[20:21]
    ds_add_rtn_u32 v217, v217, v3
    s_mov_b64 exec, s[22:23]
    ds_add_rtn_u32 v218, v218, v3
    s_mov_b64 exec, -1
    v_bfe_u32 v219, v165, 0, 8
    v_bfe_u32 v220, v165, 8, 8
    v_bfe_u32 v221, v165, 16, 8
    v_mad_u32_u24 v213, v213, s71, v75
    v_mad_u32_u24 v214, v214, s71, v75
    v_mad_u32_u24 v215, v215, s71, v75
    s_and_b64 s[10:11], vcc, s[26:27]
    s_lshr_b64 s[10:11], s[10:11], 7
    s_lshl_b64 s[12:13], s[10:11], 8
    s_sub_u32 s10, s12, s10
    s_subb_u32 s11, s13, s11
    s_waitcnt lgkmcnt(0)
    v_min_u32 v216, 192, v216
    v_min_u32 v217, 192, v217
    v_min_u32 v218, 192, v218
    v_lshl_add_u32 v213, v216, 3, v213
    v_lshl_add_u32 v214, v217, 3, v214
    v_lshl_add_u32 v215, v218, 3, v215
    s_mov_b64 exec, s[18:19]
    ds_write2_b32 v213, v162, v219 offset0:0 offset1:1
    s_mov_b64 exec, s[20:21]
    ds_write2_b32 v214, v163, v220 offset0:0 offset1:1
    s_mov_b64 exec, s[22:23]
    ds_write2_b32 v215, v164, v221 offset0:0 offset1:1
    s_mov_b64 exec, -1
    s_and_b64 s[16:17], s[16:17], s[26:27]
    s_cbranch_scc1 c_l3_3
c_l3_back_3:
    s_cmp_eq_u64 s[10:11], 0
    s_cbranch_scc1 sl_43
    s_add_u32 s62, s94, 16777216
    s_mov_b64 exec, s[10:11]
    buffer_load_dwordx4 v[162:165], v73, s[56:59], s62 offen offset:3072 sc1
    s_mov_b64 exec, -1
sl_43:
noins_42:
    s_waitcnt lgkmcnt(0)
    s_waitcnt vmcnt(3)
    v_mfma_f32_16x16x32_bf16 v[166:169], v[126:129], v[44:47], 0
    v_mfma_f32_16x16x32_bf16 v[170:173], v[126:129], v[48:51], 0
    s_cmp_gt_u32 s82, 128
    s_cbranch_scc0 skg_44
    v_cmp_gt_u32 vcc, s82, v198
    v_lshrrev_b32 v193, 9, v192
    v_and_or_b32 v193, v193, s92, v200
    v_cndmask_b32 v193, 1.0, v193, vcc
    buffer_load_dwordx4 v[142:145], v193, s[32:35], 0 offen
skg_44:
    v_and_b32 v206, 15, v190
    v_lshl_or_b32 v206, v191, 4, v206
    v_cvt_f32_u32 v206, v206
    v_and_or_b32 v205, v190, s91, v208
    v_fma_f32 v206, v206, s93, v210
    v_fma_f32 v207, v206, v206, -0.5
    v_cndmask_b32 v206, v206, v207, s[24:25]
    v_cvt_pk_bf16_f32 v206, v206, v206
    ds_write_b16 v205, v206
    ds_read_b128 v[182:185], v209
    ds_read_b128 v[186:189], v209 offset:1024
    ds_write_b16 v205, v2
    ds_read_b32 v192, v201 offset:7488
    ds_read_b64 v[190:191], v203 offset:6720
    v_cvt_pk_bf16_f32 v126, v166, v167
    v_cvt_pk_bf16_f32 v127, v168, v169
    v_cvt_pk_bf16_f32 v128, v170, v171
    v_cvt_pk_bf16_f32 v129, v172, v173
    s_nop 1
    v_mfma_f32_16x16x32_bf16 v[20:23], v[126:129], v[174:177], v[20:23]
    v_mfma_f32_16x16x32_bf16 v[24:27], v[126:129], v[178:181], v[24:27]
    s_cmp_eq_u32 s90, 0
    s_cbranch_scc1 noep_45
    v_mfma_f32_16x16x16_bf16 v[158:161], v[150:151], v[54:55], 0
    v_mfma_f32_16x16x16_bf16 v[162:165], v[152:153], v[54:55], 0
    v_mfma_f32_16x16x16_bf16 v[226:229], v[154:155], v[54:55], 0
    v_lshlrev_b32 v234, 16, v64
    v_and_b32 v235, 0xffff0000, v64
    v_lshlrev_b32 v236, 16, v65
    v_and_b32 v237, 0xffff0000, v65
    s_nop 1
    v_mul_f32 v158, v158, v12
    v_mul_f32 v159, v159, v13
    v_mul_f32 v160, v160, v14
    v_mul_f32 v161, v161, v15
    v_fma_f32 v158, v162, v16, v158
    v_fma_f32 v159, v163, v17, v159
    v_fma_f32 v160, v164, v18, v160
    v_fma_f32 v161, v165, v19, v161
    v_cvt_pk_bf16_f32 v238, v158, v159
    v_cvt_pk_bf16_f32 v239, v160, v161
    s_nop 1
    v_mfma_f32_16x16x16_bf16 v[230:233], v[156:157], v[238:239], 0
    s_nop 7
    v_fma_f32 v234, v230, v226, v234
    v_fma_f32 v235, v231, v227, v235
    v_fma_f32 v236, v232, v228, v236
    v_fma_f32 v237, v233, v229, v237
    v_cvt_pk_bf16_f32 v64, v234, v235
    v_cvt_pk_bf16_f32 v65, v236, v237
noep_45:
    s_waitcnt lgkmcnt(0)
    s_waitcnt vmcnt(2)
    v_mfma_f32_16x16x32_bf16 v[166:169], v[130:133], v[44:47], 0
    v_mfma_f32_16x16x32_bf16 v[170:173], v[130:133], v[48:51], 0
    s_cmp_gt_u32 s82, 160
    s_cbranch_scc0 skg_46
    v_cmp_gt_u32 vcc, s82, v199
    v_lshrrev_b32 v193, 9, v192
    v_and_or_b32 v193, v193, s92, v200
    v_cndmask_b32 v193, 1.0, v193, vcc
    buffer_load_dwordx4 v[146:149], v193, s[32:35], 0 offen
skg_46:
    v_and_b32 v206, 15, v190
    v_lshl_or_b32 v206, v191, 4, v206
    v_cvt_f32_u32 v206, v206
    v_and_or_b32 v205, v190, s91, v208
    v_fma_f32 v206, v206, s93, v210
    v_fma_f32 v207, v206, v206, -0.5
    v_cndmask_b32 v206, v206, v207, s[24:25]
    v_cvt_pk_bf16_f32 v206, v206, v206
    ds_write_b16 v205, v206
    ds_read_b128 v[174:177], v209
    ds_read_b128 v[178:181], v209 offset:1024
    ds_write_b16 v205, v2
    ds_read_b32 v192, v201 offset:9312
    ds_read_b64 v[190:191], v203 offset:6976
    v_cvt_pk_bf16_f32 v130, v166, v167
    v_cvt_pk_bf16_f32 v131, v168, v169
    v_cvt_pk_bf16_f32 v132, v170, v171
    v_cvt_pk_bf16_f32 v133, v172, v173
    s_nop 1
    v_mfma_f32_16x16x32_bf16 v[20:23], v[130:133], v[182:185], v[20:23]
    v_mfma_f32_16x16x32_bf16 v[24:27], v[130:133], v[186:189], v[24:27]
    s_waitcnt lgkmcnt(0)
    s_waitcnt vmcnt(1)
    v_mfma_f32_16x16x32_bf16 v[166:169], v[134:137], v[44:47], 0
    v_mfma_f32_16x16x32_bf16 v[170:173], v[134:137], v[48:51], 0
    v_cmp_gt_u32 vcc, s83, v194
    v_lshrrev_b32 v193, 9, v192
    v_and_or_b32 v193, v193, s92, v200
    v_cndmask_b32 v193, 1.0, v193, vcc
    buffer_load_dwordx4 v[126:129], v193, s[32:35], 0 offen
    v_and_b32 v206, 15, v190
    v_lshl_or_b32 v206, v191, 4, v206
    v_cvt_f32_u32 v206, v206
    v_and_or_b32 v205, v190, s91, v208
    v_fma_f32 v206, v206, s93, v210
    v_fma_f32 v207, v206, v206, -0.5
    v_cndmask_b32 v206, v206, v207, s[24:25]
    v_cvt_pk_bf16_f32 v206, v206, v206
    ds_write_b16 v205, v206
    ds_read_b128 v[182:185], v209
    ds_read_b128 v[186:189], v209 offset:1024
    ds_write_b16 v205, v2
    ds_read_b32 v192, v201 offset:9568
    ds_read_b64 v[190:191], v203 offset:7232
    v_cvt_pk_bf16_f32 v134, v166, v167
    v_cvt_pk_bf16_f32 v135, v168, v169
    v_cvt_pk_bf16_f32 v136, v170, v171
    v_cvt_pk_bf16_f32 v137, v172, v173
    s_nop 1
    v_mfma_f32_16x16x32_bf16 v[20:23], v[134:137], v[174:177], v[20:23]
    v_mfma_f32_16x16x32_bf16 v[24:27], v[134:137], v[178:181], v[24:27]
    s_waitcnt lgkmcnt(0)
    s_waitcnt vmcnt(1)
    v_mfma_f32_16x16x32_bf16 v[166:169], v[138:141], v[44:47], 0
    v_mfma_f32_16x16x32_bf16 v[170:173], v[138:141], v[48:51], 0
    v_cmp_gt_u32 vcc, s83, v195
    v_lshrrev_b32 v193, 9, v192
    v_and_or_b32 v193, v193, s92, v200
    v_cndmask_b32 v193, 1.0, v193, vcc
    buffer_load_dwordx4 v[130:133], v193, s[32:35], 0 offen
    s_cmp_gt_u32 s82, 128
    s_cbranch_scc0 sk2_47
    v_and_b32 v206, 15, v190
    v_lshl_or_b32 v206, v191, 4, v206
    v_cvt_f32_u32 v206, v206
    v_and_or_b32 v205, v190, s91, v208
    v_fma_f32 v206, v206, s93, v210
    v_fma_f32 v207, v206, v206, -0.5
    v_cndmask_b32 v206, v206, v207, s[24:25]
    v_cvt_pk_bf16_f32 v206, v206, v206
    ds_write_b16 v205, v206
    ds_read_b128 v[174:177], v209
    ds_read_b128 v[178:181], v209 offset:1024
    ds_write_b16 v205, v2
sk2_47:
    ds_read_b32 v192, v201 offset:9824
    ds_read_b64 v[190:191], v203 offset:7488
    v_cvt_pk_bf16_f32 v138, v166, v167
    v_cvt_pk_bf16_f32 v139, v168, v169
    v_cvt_pk_bf16_f32 v140, v170, v171
    v_cvt_pk_bf16_f32 v141, v172, v173
    s_nop 1
    v_mfma_f32_16x16x32_bf16 v[20:23], v[138:141], v[182:185], v[20:23]
    v_mfma_f32_16x16x32_bf16 v[24:27], v[138:141], v[186:189], v[24:27]
    s_waitcnt lgkmcnt(0)
    s_cmp_gt_u32 s82, 128
    s_cbranch_scc0 sk1_48
    s_waitcnt vmcnt(2)
    v_mfma_f32_16x16x32_bf16 v[166:169], v[142:145], v[44:47], 0
    v_mfma_f32_16x16x32_bf16 v[170:173], v[142:145], v[48:51], 0
sk1_48:
    v_cmp_gt_u32 vcc, s83, v196
    v_lshrrev_b32 v193, 9, v192
    v_and_or_b32 v193, v193, s92, v200
    v_cndmask_b32 v193, 1.0, v193, vcc
    buffer_load_dwordx4 v[134:137], v193, s[32:35], 0 offen
    s_cmp_gt_u32 s82, 160
    s_cbranch_scc0 sk2_49
    v_and_b32 v206, 15, v190
    v_lshl_or_b32 v206, v191, 4, v206
    v_cvt_f32_u32 v206, v206
    v_and_or_b32 v205, v190, s91, v208
    v_fma_f32 v206, v206, s93, v210
    v_fma_f32 v207, v206, v206, -0.5
    v_cndmask_b32 v206, v206, v207, s[24:25]
    v_cvt_pk_bf16_f32 v206, v206, v206
    ds_write_b16 v205, v206
    ds_read_b128 v[182:185], v209
    ds_read_b128 v[186:189], v209 offset:1024
    ds_write_b16 v205, v2
sk2_49:
    ds_read_b32 v192, v201 offset:10080
    ds_read_b64 v[190:191], v203 offset:9312
    s_cmp_gt_u32 s82, 128
    s_cbranch_scc0 sk3_50
    v_cvt_pk_bf16_f32 v142, v166, v167
    v_cvt_pk_bf16_f32 v143, v168, v169
    v_cvt_pk_bf16_f32 v144, v170, v171
    v_cvt_pk_bf16_f32 v145, v172, v173
    s_nop 1
    v_mfma_f32_16x16x32_bf16 v[20:23], v[142:145], v[174:177], v[20:23]
    v_mfma_f32_16x16x32_bf16 v[24:27], v[142:145], v[178:181], v[24:27]
sk3_50:
    s_cmp_eq_u32 s90, 0
    s_cbranch_scc0 noarr_51
    s_cmp_eq_u64 s[4:5], 0
    s_cbranch_scc1 sn_52
    s_waitcnt vmcnt(6)
    s_mov_b64 exec, s[4:5]
    v_perm_b32 v223, v153, v153, v74
    s_nop 1
    v_or_b32_dpp v223, v223, v223 quad_perm:[1,0,3,2] row_mask:0xf bank_mask:0xf
    s_nop 1
    v_or_b32_dpp v223, v223, v223 quad_perm:[2,3,0,1] row_mask:0xf bank_mask:0xf
    v_lshlrev_b32 v224, 8, v223
    v_xad_u32 v223, v223, v224, s68
    v_cmp_le_u32 vcc, 8, v223
    s_cbranch_vccnz c_rp_s0
c_ok_s0:
    v_cmp_gt_u32 s[18:19], s69, v150
    v_cmp_gt_u32 s[20:21], s69, v151
    v_cmp_gt_u32 s[22:23], s69, v152
    v_bfe_u32 v213, v150, 8, 6
    v_bfe_u32 v214, v151, 8, 6
    v_bfe_u32 v215, v152, 8, 6
    v_lshl_or_b32 v213, v213, 1, 1
    v_lshl_or_b32 v214, v214, 1, 1
    v_lshl_or_b32 v215, v215, 1, 1
    v_lshl_add_u32 v216, v213, 2, 64
    v_lshl_add_u32 v217, v214, 2, 64
    v_lshl_add_u32 v218, v215, 2, 64
    s_mov_b64 exec, s[18:19]
    ds_add_rtn_u32 v216, v216, v3
    s_mov_b64 exec, s[20:21]
    ds_add_rtn_u32 v217, v217, v3
    s_mov_b64 exec, s[22:23]
    ds_add_rtn_u32 v218, v218, v3
    s_mov_b64 exec, -1
    v_bfe_u32 v219, v153, 0, 8
    v_bfe_u32 v220, v153, 8, 8
    v_bfe_u32 v221, v153, 16, 8
    v_mad_u32_u24 v213, v213, s71, v75
    v_mad_u32_u24 v214, v214, s71, v75
    v_mad_u32_u24 v215, v215, s71, v75
    s_waitcnt lgkmcnt(0)
    v_min_u32 v216, 192, v216
    v_min_u32 v217, 192, v217
    v_min_u32 v218, 192, v218
    v_lshl_add_u32 v213, v216, 3, v213
    v_lshl_add_u32 v214, v217, 3, v214
    v_lshl_add_u32 v215, v218, 3, v215
    s_mov_b64 exec, s[18:19]
    ds_write2_b32 v213, v150, v219 offset0:0 offset1:1
    s_mov_b64 exec, s[20:21]
    ds_write2_b32 v214, v151, v220 offset0:0 offset1:1
    s_mov_b64 exec, s[22:23]
    ds_write2_b32 v215, v152, v221 offset0:0 offset1:1
    s_mov_b64 exec, -1
sn_52:
    s_cmp_eq_u64 s[6:7], 0
    s_cbranch_scc1 sn_53
    s_waitcnt vmcnt(5)
    s_mov_b64 exec, s[6:7]
    v_perm_b32 v223, v157, v157, v74
    s_nop 1
    v_or_b32_dpp v223, v223, v223 quad_perm:[1,0,3,2] row_mask:0xf bank_mask:0xf
    s_nop 1
    v_or_b32_dpp v223, v223, v223 quad_perm:[2,3,0,1] row_mask:0xf bank_mask:0xf
    v_lshlrev_b32 v224, 8, v223
    v_xad_u32 v223, v223, v224, s68
    v_cmp_le_u32 vcc, 8, v223
    s_cbranch_vccnz c_rp_s1
c_ok_s1:
    v_cmp_gt_u32 s[18:19], s69, v154
    v_cmp_gt_u32 s[20:21], s69, v155
    v_cmp_gt_u32 s[22:23], s69, v156
    v_bfe_u32 v213, v154, 8, 6
    v_bfe_u32 v214, v155, 8, 6
    v_bfe_u32 v215, v156, 8, 6
    v_lshl_or_b32 v213, v213, 1, 1
    v_lshl_or_b32 v214, v214, 1, 1
    v_lshl_or_b32 v215, v215, 1, 1
    v_lshl_add_u32 v216, v213, 2, 64
    v_lshl_add_u32 v217, v214, 2, 64
    v_lshl_add_u32 v218, v215, 2, 64
    s_mov_b64 exec, s[18:19]
    ds_add_rtn_u32 v216, v216, v3
    s_mov_b64 exec, s[20:21]
    ds_add_rtn_u32 v217, v217, v3
    s_mov_b64 exec, s[22:23]
    ds_add_rtn_u32 v218, v218, v3
    s_mov_b64 exec, -1
    v_bfe_u32 v219, v157, 0, 8
    v_bfe_u32 v220, v157, 8, 8
    v_bfe_u32 v221, v157, 16, 8
    v_mad_u32_u24 v213, v213, s71, v75
    v_mad_u32_u24 v214, v214, s71, v75
    v_mad_u32_u24 v215, v215, s71, v75
    s_waitcnt lgkmcnt(0)
    v_min_u32 v216, 192, v216
    v_min_u32 v217, 192, v217
    v_min_u32 v218, 192, v218
    v_lshl_add_u32 v213, v216, 3, v213
    v_lshl_add_u32 v214, v217, 3, v214
    v_lshl_add_u32 v215, v218, 3, v215
    s_mov_b64 exec, s[18:19]
    ds_write2_b32 v213, v154, v219 offset0:0 offset1:1
    s_mov_b64 exec, s[20:21]
    ds_write2_b32 v214, v155, v220 offset0:0 offset1:1
    s_mov_b64 exec, s[22:23]
    ds_write2_b32 v215, v156, v221 offset0:0 offset1:1
    s_mov_b64 exec, -1
sn_53:
    s_cmp_eq_u64 s[8:9], 0
    s_cbranch_scc1 sn_54
    s_waitcnt vmcnt(4)
    s_mov_b64 exec, s[8:9]
    v_perm_b32 v223, v161, v161, v74
    s_nop 1
    v_or_b32_dpp v223, v223, v223 quad_perm:[1,0,3,2] row_mask:0xf bank_mask:0xf
    s_nop 1
    v_or_b32_dpp v223, v223, v223 quad_perm:[2,3,0,1] row_mask:0xf bank_mask:0xf
    v_lshlrev_b32 v224, 8, v223
    v_xad_u32 v223, v223, v224, s68
    v_cmp_le_u32 vcc, 8, v223
    s_cbranch_vccnz c_rp_s2
c_ok_s2:
    v_cmp_gt_u32 s[18:19], s69, v158
    v_cmp_gt_u32 s[20:21], s69, v159
    v_cmp_gt_u32 s[22:23], s69, v160
    v_bfe_u32 v213, v158, 8, 6
    v_bfe_u32 v214, v159, 8, 6
    v_bfe_u32 v215, v160, 8, 6
    v_lshl_or_b32 v213, v213, 1, 1
    v_lshl_or_b32 v214, v214, 1, 1
    v_lshl_or_b32 v215, v215, 1, 1
    v_lshl_add_u32 v216, v213, 2, 64
    v_lshl_add_u32 v217, v214, 2, 64
    v_lshl_add_u32 v218, v215, 2, 64
    s_mov_b64 exec, s[18:19]
    ds_add_rtn_u32 v216, v216, v3
    s_mov_b64 exec, s[20:21]
    ds_add_rtn_u32 v217, v217, v3
    s_mov_b64 exec, s[22:23]
    ds_add_rtn_u32 v218, v218, v3
    s_mov_b64 exec, -1
    v_bfe_u32 v219, v161, 0, 8
    v_bfe_u32 v220, v161, 8, 8
    v_bfe_u32 v221, v161, 16, 8
    v_mad_u32_u24 v213, v213, s71, v75
    v_mad_u32_u24 v214, v214, s71, v75
    v_mad_u32_u24 v215, v215, s71, v75
    s_waitcnt lgkmcnt(0)
    v_min_u32 v216, 192, v216
    v_min_u32 v217, 192, v217
    v_min_u32 v218, 192, v218
    v_lshl_add_u32 v213, v216, 3, v213
    v_lshl_add_u32 v214, v217, 3, v214
    v_lshl_add_u32 v215, v218, 3, v215
    s_mov_b64 exec, s[18:19]
    ds_write2_b32 v213, v158, v219 offset0:0 offset1:1
    s_mov_b64 exec, s[20:21]
    ds_write2_b32 v214, v159, v220 offset0:0 offset1:1
    s_mov_b64 exec, s[22:23]
    ds_write2_b32 v215, v160, v221 offset0:0 offset1:1
    s_mov_b64 exec, -1
sn_54:
    s_cmp_eq_u64 s[10:11], 0
    s_cbranch_scc1 sn_55
    s_waitcnt vmcnt(3)
    s_mov_b64 exec, s[10:11]
    v_perm_b32 v223, v165, v165, v74
    s_nop 1
    v_or_b32_dpp v223, v223, v223 quad_perm:[1,0,3,2] row_mask:0xf bank_mask:0xf
    s_nop 1
    v_or_b32_dpp v223, v223, v223 quad_perm:[2,3,0,1] row_mask:0xf bank_mask:0xf
    v_lshlrev_b32 v224, 8, v223
    v_xad_u32 v223, v223, v224, s68
    v_cmp_le_u32 vcc, 8, v223
    s_cbranch_vccnz c_rp_s3
c_ok_s3:
    v_cmp_gt_u32 s[18:19], s69, v162
    v_cmp_gt_u32 s[20:21], s69, v163
    v_cmp_gt_u32 s[22:23], s69, v164
    v_bfe_u32 v213, v162, 8, 6
    v_bfe_u32 v214, v163, 8, 6
    v_bfe_u32 v215, v164, 8, 6
    v_lshl_or_b32 v213, v213, 1, 1
    v_lshl_or_b32 v214, v214, 1, 1
    v_lshl_or_b32 v215, v215, 1, 1
    v_lshl_add_u32 v216, v213, 2, 64
    v_lshl_add_u32 v217, v214, 2, 64
    v_lshl_add_u32 v218, v215, 2, 64
    s_mov_b64 exec, s[18:19]
    ds_add_rtn_u32 v216, v216, v3
    s_mov_b64 exec, s[20:21]
    ds_add_rtn_u32 v217, v217, v3
    s_mov_b64 exec, s[22:23]
    ds_add_rtn_u32 v218, v218, v3
    s_mov_b64 exec, -1
    v_bfe_u32 v219, v165, 0, 8
    v_bfe_u32 v220, v165, 8, 8
    v_bfe_u32 v221, v165, 16, 8
    v_mad_u32_u24 v213, v213, s71, v75
    v_mad_u32_u24 v214, v214, s71, v75
    v_mad_u32_u24 v215, v215, s71, v75
    s_waitcnt lgkmcnt(0)
    v_min_u32 v216, 192, v216
    v_min_u32 v217, 192, v217
    v_min_u32 v218, 192, v218
    v_lshl_add_u32 v213, v216, 3, v213
    v_lshl_add_u32 v214, v217, 3, v214
    v_lshl_add_u32 v215, v218, 3, v215
    s_mov_b64 exec, s[18:19]
    ds_write2_b32 v213, v162, v219 offset0:0 offset1:1
    s_mov_b64 exec, s[20:21]
    ds_write2_b32 v214, v163, v220 offset0:0 offset1:1
    s_mov_b64 exec, s[22:23]
    ds_write2_b32 v215, v164, v221 offset0:0 offset1:1
    s_mov_b64 exec, -1
sn_55:
    s_cmp_eq_u32 s61, 0
    s_cbranch_scc1 pub_56
    ds_write_b32 v2, v3 offset:16
pub_56:
    s_waitcnt lgkmcnt(0)
    s_mov_b64 exec, 1
    ds_add_u32 v2, v3 offset:8
    s_mov_b64 exec, -1
noarr_51:
    s_waitcnt lgkmcnt(0)
    s_cmp_gt_u32 s82, 160
    s_cbranch_scc0 sk1_57
    s_waitcnt vmcnt(3)
    v_mfma_f32_16x16x32_bf16 v[166:169], v[146:149], v[44:47], 0
    v_mfma_f32_16x16x32_bf16 v[170:173], v[146:149], v[48:51], 0
sk1_57:
    v_cmp_gt_u32 vcc, s83, v197
    v_lshrrev_b32 v193, 9, v192
    v_and_or_b32 v193, v193, s92, v200
    v_cndmask_b32 v193, 1.0, v193, vcc
    buffer_load_dwordx4 v[138:141], v193, s[32:35], 0 offen
    v_and_b32 v206, 15, v190
    v_lshl_or_b32 v206, v191, 4, v206
    v_cvt_f32_u32 v206, v206
    v_and_or_b32 v205, v190, s91, v208
    v_fma_f32 v206, v206, s93, v210
    v_fma_f32 v207, v206, v206, -0.5
    v_cndmask_b32 v206, v206, v207, s[24:25]
    v_cvt_pk_bf16_f32 v206, v206, v206
    ds_write_b16 v205, v206
    ds_read_b128 v[174:177], v209
    ds_read_b128 v[178:181], v209 offset:1024
    ds_write_b16 v205, v2
    ds_read_b32 v192, v201 offset:10336
    ds_read_b64 v[190:191], v203 offset:9568
    s_cmp_gt_u32 s82, 160
    s_cbranch_scc0 sk3_58
    v_cvt_pk_bf16_f32 v146, v166, v167
    v_cvt_pk_bf16_f32 v147, v168, v169
    v_cvt_pk_bf16_f32 v148, v170, v171
    v_cvt_pk_bf16_f32 v149, v172, v173
    s_nop 1
    v_mfma_f32_16x16x32_bf16 v[20:23], v[146:149], v[182:185], v[20:23]
    v_mfma_f32_16x16x32_bf16 v[24:27], v[146:149], v[186:189], v[24:27]
sk3_58:
    s_waitcnt lgkmcnt(0)
    s_waitcnt vmcnt(3)
    v_mfma_f32_16x16x32_bf16 v[166:169], v[126:129], v[44:47], 0
    v_mfma_f32_16x16x32_bf16 v[170:173], v[126:129], v[48:51], 0
    s_cmp_gt_u32 s83, 128
    s_cbranch_scc0 skg_59
    v_cmp_gt_u32 vcc, s83, v198
    v_lshrrev_b32 v193, 9, v192
    v_and_or_b32 v193, v193, s92, v200
    v_cndmask_b32 v193, 1.0, v193, vcc
    buffer_load_dwordx4 v[142:145], v193, s[32:35], 0 offen
skg_59:
    v_and_b32 v206, 15, v190
    v_lshl_or_b32 v206, v191, 4, v206
    v_cvt_f32_u32 v206, v206
    v_and_or_b32 v205, v190, s91, v208
    v_fma_f32 v206, v206, s93, v210
    v_fma_f32 v207, v206, v206, -0.5
    v_cndmask_b32 v206, v206, v207, s[24:25]
    v_cvt_pk_bf16_f32 v206, v206, v206
    ds_write_b16 v205, v206
    ds_read_b128 v[182:185], v209
    ds_read_b128 v[186:189], v209 offset:1024
    ds_write_b16 v205, v2
    ds_read_b32 v192, v201 offset:10592
    ds_read_b64 v[190:191], v203 offset:9824
    v_cvt_pk_bf16_f32 v126, v166, v167
    v_cvt_pk_bf16_f32 v127, v168, v169
    v_cvt_pk_bf16_f32 v128, v170, v171
    v_cvt_pk_bf16_f32 v129, v172, v173
    s_nop 1
    v_mfma_f32_16x16x32_bf16 v[28:31], v[126:129], v[174:177], v[28:31]
    v_mfma_f32_16x16x32_bf16 v[32:35], v[126:129], v[178:181], v[32:35]
    s_cmp_eq_u32 s90, 0
    s_cbranch_scc1 noep_60
    v_mfma_f32_16x16x16_bf16 v[158:161], v[150:151], v[56:57], 0
    v_mfma_f32_16x16x16_bf16 v[162:165], v[152:153], v[56:57], 0
    v_mfma_f32_16x16x16_bf16 v[226:229], v[154:155], v[56:57], 0
    v_lshlrev_b32 v234, 16, v66
    v_and_b32 v235, 0xffff0000, v66
    v_lshlrev_b32 v236, 16, v67
    v_and_b32 v237, 0xffff0000, v67
    s_nop 1
    v_mul_f32 v158, v158, v20
    v_mul_f32 v159, v159, v21
    v_mul_f32 v160, v160, v22
    v_mul_f32 v161, v161, v23
    v_fma_f32 v158, v162, v24, v158
    v_fma_f32 v159, v163, v25, v159
    v_fma_f32 v160, v164, v26, v160
    v_fma_f32 v161, v165, v27, v161
    v_cvt_pk_bf16_f32 v238, v158, v159
    v_cvt_pk_bf16_f32 v239, v160, v161
    s_nop 1
    v_mfma_f32_16x16x16_bf16 v[230:233], v[156:157], v[238:239], 0
    s_nop 7
    v_fma_f32 v234, v230, v226, v234
    v_fma_f32 v235, v231, v227, v235
    v_fma_f32 v236, v232, v228, v236
    v_fma_f32 v237, v233, v229, v237
    v_cvt_pk_bf16_f32 v66, v234, v235
    v_cvt_pk_bf16_f32 v67, v236, v237
noep_60:
    s_waitcnt lgkmcnt(0)
    s_waitcnt vmcnt(2)
    v_mfma_f32_16x16x32_bf16 v[166:169], v[130:133], v[44:47], 0
    v_mfma_f32_16x16x32_bf16 v[170:173], v[130:133], v[48:51], 0
    s_cmp_gt_u32 s83, 160
    s_cbranch_scc0 skg_61
    v_cmp_gt_u32 vcc, s83, v199
    v_lshrrev_b32 v193, 9, v192
    v_and_or_b32 v193, v193, s92, v200
    v_cndmask_b32 v193, 1.0, v193, vcc
    buffer_load_dwordx4 v[146:149], v193, s[32:35], 0 offen
skg_61:
    v_and_b32 v206, 15, v190
    v_lshl_or_b32 v206, v191, 4, v206
    v_cvt_f32_u32 v206, v206
    v_and_or_b32 v205, v190, s91, v208
    v_fma_f32 v206, v206, s93, v210
    v_fma_f32 v207, v206, v206, -0.5
    v_cndmask_b32 v206, v206, v207, s[24:25]
    v_cvt_pk_bf16_f32 v206, v206, v206
    ds_write_b16 v205, v206
    ds_read_b128 v[174:177], v209
    ds_read_b128 v[178:181], v209 offset:1024
    ds_write_b16 v205, v2
    ds_read_b32 v192, v201 offset:12416
    ds_read_b64 v[190:191], v203 offset:10080
    v_cvt_pk_bf16_f32 v130, v166, v167
    v_cvt_pk_bf16_f32 v131, v168, v169
    v_cvt_pk_bf16_f32 v132, v170, v171
    v_cvt_pk_bf16_f32 v133, v172, v173
    s_nop 1
    v_mfma_f32_16x16x32_bf16 v[28:31], v[130:133], v[182:185], v[28:31]
    v_mfma_f32_16x16x32_bf16 v[32:35], v[130:133], v[186:189], v[32:35]
    s_waitcnt lgkmcnt(0)
    s_waitcnt vmcnt(1)
    v_mfma_f32_16x16x32_bf16 v[166:169], v[134:137], v[44:47], 0
    v_mfma_f32_16x16x32_bf16 v[170:173], v[134:137], v[48:51], 0
    v_cmp_gt_u32 vcc, s84, v194
    v_lshrrev_b32 v193, 9, v192
    v_and_or_b32 v193, v193, s92, v200
    v_cndmask_b32 v193, 1.0, v193, vcc
    buffer_load_dwordx4 v[126:129], v193, s[32:35], 0 offen
    v_and_b32 v206, 15, v190
    v_lshl_or_b32 v206, v191, 4, v206
    v_cvt_f32_u32 v206, v206
    v_and_or_b32 v205, v190, s91, v208
    v_fma_f32 v206, v206, s93, v210
    v_fma_f32 v207, v206, v206, -0.5
    v_cndmask_b32 v206, v206, v207, s[24:25]
    v_cvt_pk_bf16_f32 v206, v206, v206
    ds_write_b16 v205, v206
    ds_read_b128 v[182:185], v209
    ds_read_b128 v[186:189], v209 offset:1024
    ds_write_b16 v205, v2
    ds_read_b32 v192, v201 offset:12672
    ds_read_b64 v[190:191], v203 offset:10336
    v_cvt_pk_bf16_f32 v134, v166, v167
    v_cvt_pk_bf16_f32 v135, v168, v169
    v_cvt_pk_bf16_f32 v136, v170, v171
    v_cvt_pk_bf16_f32 v137, v172, v173
    s_nop 1
    v_mfma_f32_16x16x32_bf16 v[28:31], v[134:137], v[174:177], v[28:31]
    v_mfma_f32_16x16x32_bf16 v[32:35], v[134:137], v[178:181], v[32:35]
    s_waitcnt lgkmcnt(0)
    s_waitcnt vmcnt(1)
    v_mfma_f32_16x16x32_bf16 v[166:169], v[138:141], v[44:47], 0
    v_mfma_f32_16x16x32_bf16 v[170:173], v[138:141], v[48:51], 0
    v_cmp_gt_u32 vcc, s84, v195
    v_lshrrev_b32 v193, 9, v192
    v_and_or_b32 v193, v193, s92, v200
    v_cndmask_b32 v193, 1.0, v193, vcc
    buffer_load_dwordx4 v[130:133], v193, s[32:35], 0 offen
    s_cmp_gt_u32 s83, 128
    s_cbranch_scc0 sk2_62
    v_and_b32 v206, 15, v190
    v_lshl_or_b32 v206, v191, 4, v206
    v_cvt_f32_u32 v206, v206
    v_and_or_b32 v205, v190, s91, v208
    v_fma_f32 v206, v206, s93, v210
    v_fma_f32 v207, v206, v206, -0.5
    v_cndmask_b32 v206, v206, v207, s[24:25]
    v_cvt_pk_bf16_f32 v206, v206, v206
    ds_write_b16 v205, v206
    ds_read_b128 v[174:177], v209
    ds_read_b128 v[178:181], v209 offset:1024
    ds_write_b16 v205, v2
sk2_62:
    ds_read_b32 v192, v201 offset:12928
    ds_read_b64 v[190:191], v203 offset:10592
    v_cvt_pk_bf16_f32 v138, v166, v167
    v_cvt_pk_bf16_f32 v139, v168, v169
    v_cvt_pk_bf16_f32 v140, v170, v171
    v_cvt_pk_bf16_f32 v141, v172, v173
    s_nop 1
    v_mfma_f32_16x16x32_bf16 v[28:31], v[138:141], v[182:185], v[28:31]
    v_mfma_f32_16x16x32_bf16 v[32:35], v[138:141], v[186:189], v[32:35]
    s_waitcnt lgkmcnt(0)
    s_cmp_gt_u32 s83, 128
    s_cbranch_scc0 sk1_63
    s_waitcnt vmcnt(2)
    v_mfma_f32_16x16x32_bf16 v[166:169], v[142:145], v[44:47], 0
    v_mfma_f32_16x16x32_bf16 v[170:173], v[142:145], v[48:51], 0
sk1_63:
    s_cmp_eq_u32 s90, 0
    s_cbranch_scc0 nowait_64
spin_66:
    ds_read_b32 v212, v2 offset:8
    s_waitcnt lgkmcnt(0)
    v_readfirstlane_b32 s62, v212
    s_cmp_ge_u32 s62, 8
    s_cbranch_scc1 spinx_67
    s_sleep 1
    s_branch spin_66
spinx_67:
    ds_read_b32 v212, v211 offset:68
    ds_read_b32 v218, v2 offset:16
    s_branch gowait_65
nowait_64:
    v_mov_b32 v212, 0
    v_mov_b32 v218, 0
gowait_65:
    v_cmp_gt_u32 vcc, s84, v196
    v_lshrrev_b32 v193, 9, v192
    v_and_or_b32 v193, v193, s92, v200
    v_cndmask_b32 v193, 1.0, v193, vcc
    buffer_load_dwordx4 v[134:137], v193, s[32:35], 0 offen
    s_cmp_gt_u32 s83, 160
    s_cbranch_scc0 sk2_68
    v_and_b32 v206, 15, v190
    v_lshl_or_b32 v206, v191, 4, v206
    v_cvt_f32_u32 v206, v206
    v_and_or_b32 v205, v190, s91, v208
    v_fma_f32 v206, v206, s93, v210
    v_fma_f32 v207, v206, v206, -0.5
    v_cndmask_b32 v206, v206, v207, s[24:25]
    v_cvt_pk_bf16_f32 v206, v206, v206
    ds_write_b16 v205, v206
    ds_read_b128 v[182:185], v209
    ds_read_b128 v[186:189], v209 offset:1024
    ds_write_b16 v205, v2
sk2_68:
    ds_read_b32 v192, v201 offset:13184
    ds_read_b64 v[190:191], v203 offset:12416
    s_cmp_gt_u32 s83, 128
    s_cbranch_scc0 sk3_69
    v_cvt_pk_bf16_f32 v142, v166, v167
    v_cvt_pk_bf16_f32 v143, v168, v169
    v_cvt_pk_bf16_f32 v144, v170, v171
    v_cvt_pk_bf16_f32 v145, v172, v173
    s_nop 1
    v_mfma_f32_16x16x32_bf16 v[28:31], v[142:145], v[174:177], v[28:31]
    v_mfma_f32_16x16x32_bf16 v[32:35], v[142:145], v[178:181], v[32:35]
sk3_69:
    s_waitcnt lgkmcnt(0)
    v_readlane_b32 s85, v212, 0
    v_readlane_b32 s86, v212, 1
    v_readlane_b32 s87, v212, 2
    v_readlane_b32 s88, v212, 3
    v_readlane_b32 s89, v212, 4
    s_max_u32 s62, s85, s86
    s_max_u32 s63, s87, s88
    s_max_u32 s62, s62, s89
    s_max_u32 s62, s62, s63
    s_cmp_gt_u32 s62, 192
    s_cselect_b32 s62, 1, 0
    s_or_b32 s61, s61, s62
    s_min_u32 s85, s85, 192
    s_min_u32 s86, s86, 192
    s_min_u32 s87, s87, 192
    s_min_u32 s88, s88, 192
    s_min_u32 s89, s89, 192
    v_readfirstlane_b32 s62, v218
    s_or_b32 s61, s61, s62
    s_cmp_gt_u32 s83, 160
    s_cbranch_scc0 sk1_70
    s_waitcnt vmcnt(3)
    v_mfma_f32_16x16x32_bf16 v[166:169], v[146:149], v[44:47], 0
    v_mfma_f32_16x16x32_bf16 v[170:173], v[146:149], v[48:51], 0
sk1_70:
    v_cmp_gt_u32 vcc, s84, v197
    v_lshrrev_b32 v193, 9, v192
    v_and_or_b32 v193, v193, s92, v200
    v_cndmask_b32 v193, 1.0, v193, vcc
    buffer_load_dwordx4 v[138:141], v193, s[32:35], 0 offen
    v_and_b32 v206, 15, v190
    v_lshl_or_b32 v206, v191, 4, v206
    v_cvt_f32_u32 v206, v206
    v_and_or_b32 v205, v190, s91, v208
    v_fma_f32 v206, v206, s93, v210
    v_fma_f32 v207, v206, v206, -0.5
    v_cndmask_b32 v206, v206, v207, s[24:25]
    v_cvt_pk_bf16_f32 v206, v206, v206
    ds_write_b16 v205, v206
    ds_read_b128 v[174:177], v209
    ds_read_b128 v[178:181], v209 offset:1024
    ds_write_b16 v205, v2
    ds_read_b32 v192, v201 offset:13440
    ds_read_b64 v[190:191], v203 offset:12672
    s_cmp_gt_u32 s83, 160
    s_cbranch_scc0 sk3_71
    v_cvt_pk_bf16_f32 v146, v166, v167
    v_cvt_pk_bf16_f32 v147, v168, v169
    v_cvt_pk_bf16_f32 v148, v170, v171
    v_cvt_pk_bf16_f32 v149, v172, v173
    s_nop 1
    v_mfma_f32_16x16x32_bf16 v[28:31], v[146:149], v[182:185], v[28:31]
    v_mfma_f32_16x16x32_bf16 v[32:35], v[146:149], v[186:189], v[32:35]
sk3_71:
    s_waitcnt lgkmcnt(0)
    s_waitcnt vmcnt(3)
    v_mfma_f32_16x16x32_bf16 v[166:169], v[126:129], v[44:47], 0
    v_mfma_f32_16x16x32_bf16 v[170:173], v[126:129], v[48:51], 0
    s_cmp_gt_u32 s84, 128
    s_cbranch_scc0 skg_72
    v_cmp_gt_u32 vcc, s84, v198
    v_lshrrev_b32 v193, 9, v192
    v_and_or_b32 v193, v193, s92, v200
    v_cndmask_b32 v193, 1.0, v193, vcc
    buffer_load_dwordx4 v[142:145], v193, s[32:35], 0 offen
skg_72:
    v_and_b32 v206, 15, v190
    v_lshl_or_b32 v206, v191, 4, v206
    v_cvt_f32_u32 v206, v206
    v_and_or_b32 v205, v190, s91, v208
    v_fma_f32 v206, v206, s93, v210
    v_fma_f32 v207, v206, v206, -0.5
    v_cndmask_b32 v206, v206, v207, s[24:25]
    v_cvt_pk_bf16_f32 v206, v206, v206
    ds_write_b16 v205, v206
    ds_read_b128 v[182:185], v209
    ds_read_b128 v[186:189], v209 offset:1024
    ds_write_b16 v205, v2
    ds_read_b32 v192, v201 offset:13696
    ds_read_b64 v[190:191], v203 offset:12928
    v_cvt_pk_bf16_f32 v126, v166, v167
    v_cvt_pk_bf16_f32 v127, v168, v169
    v_cvt_pk_bf16_f32 v128, v170, v171
    v_cvt_pk_bf16_f32 v129, v172, v173
    s_nop 1
    v_mfma_f32_16x16x32_bf16 v[36:39], v[126:129], v[174:177], v[36:39]
    v_mfma_f32_16x16x32_bf16 v[40:43], v[126:129], v[178:181], v[40:43]
    s_cmp_eq_u32 s90, 0
    s_cbranch_scc1 noep_73
    v_mfma_f32_16x16x16_bf16 v[158:161], v[150:151], v[58:59], 0
    v_mfma_f32_16x16x16_bf16 v[162:165], v[152:153], v[58:59], 0
    v_mfma_f32_16x16x16_bf16 v[226:229], v[154:155], v[58:59], 0
    v_lshlrev_b32 v234, 16, v68
    v_and_b32 v235, 0xffff0000, v68
    v_lshlrev_b32 v236, 16, v69
    v_and_b32 v237, 0xffff0000, v69
    s_nop 1
    v_mul_f32 v158, v158, v28
    v_mul_f32 v159, v159, v29
    v_mul_f32 v160, v160, v30
    v_mul_f32 v161, v161, v31
    v_fma_f32 v158, v162, v32, v158
    v_fma_f32 v159, v163, v33, v159
    v_fma_f32 v160, v164, v34, v160
    v_fma_f32 v161, v165, v35, v161
    v_cvt_pk_bf16_f32 v238, v158, v159
    v_cvt_pk_bf16_f32 v239, v160, v161
    s_nop 1
    v_mfma_f32_16x16x16_bf16 v[230:233], v[156:157], v[238:239], 0
    s_nop 7
    v_fma_f32 v234, v230, v226, v234
    v_fma_f32 v235, v231, v227, v235
    v_fma_f32 v236, v232, v228, v236
    v_fma_f32 v237, v233, v229, v237
    v_cvt_pk_bf16_f32 v68, v234, v235
    v_cvt_pk_bf16_f32 v69, v236, v237
noep_73:
    s_waitcnt lgkmcnt(0)
    s_waitcnt vmcnt(2)
    v_mfma_f32_16x16x32_bf16 v[166:169], v[130:133], v[44:47], 0
    v_mfma_f32_16x16x32_bf16 v[170:173], v[130:133], v[48:51], 0
    s_cmp_gt_u32 s84, 160
    s_cbranch_scc0 skg_74
    v_cmp_gt_u32 vcc, s84, v199
    v_lshrrev_b32 v193, 9, v192
    v_and_or_b32 v193, v193, s92, v200
    v_cndmask_b32 v193, 1.0, v193, vcc
    buffer_load_dwordx4 v[146:149], v193, s[32:35], 0 offen
skg_74:
    v_and_b32 v206, 15, v190
    v_lshl_or_b32 v206, v191, 4, v206
    v_cvt_f32_u32 v206, v206
    v_and_or_b32 v205, v190, s91, v208
    v_fma_f32 v206, v206, s93, v210
    v_fma_f32 v207, v206, v206, -0.5
    v_cndmask_b32 v206, v206, v207, s[24:25]
    v_cvt_pk_bf16_f32 v206, v206, v206
    ds_write_b16 v205, v206
    ds_read_b128 v[174:177], v209
    ds_read_b128 v[178:181], v209 offset:1024
    ds_write_b16 v205, v2
    ds_read_b32 v192, v202 offset:0
    ds_read_b64 v[190:191], v203 offset:13184
    v_cvt_pk_bf16_f32 v130, v166, v167
    v_cvt_pk_bf16_f32 v131, v168, v169
    v_cvt_pk_bf16_f32 v132, v170, v171
    v_cvt_pk_bf16_f32 v133, v172, v173
    s_nop 1
    v_mfma_f32_16x16x32_bf16 v[36:39], v[130:133], v[182:185], v[36:39]
    v_mfma_f32_16x16x32_bf16 v[40:43], v[130:133], v[186:189], v[40:43]
    s_waitcnt lgkmcnt(0)
    s_waitcnt vmcnt(1)
    v_mfma_f32_16x16x32_bf16 v[166:169], v[134:137], v[44:47], 0
    v_mfma_f32_16x16x32_bf16 v[170:173], v[134:137], v[48:51], 0
    v_cmp_gt_u32 vcc, s85, v194
    v_lshrrev_b32 v193, 9, v192
    v_and_or_b32 v193, v193, s92, v200
    v_cndmask_b32 v193, 1.0, v193, vcc
    buffer_load_dwordx4 v[126:129], v193, s[32:35], 0 offen
    v_and_b32 v206, 15, v190
    v_lshl_or_b32 v206, v191, 4, v206
    v_cvt_f32_u32 v206, v206
    v_and_or_b32 v205, v190, s91, v208
    v_fma_f32 v206, v206, s93, v210
    v_fma_f32 v207, v206, v206, -0.5
    v_cndmask_b32 v206, v206, v207, s[24:25]
    v_cvt_pk_bf16_f32 v206, v206, v206
    ds_write_b16 v205, v206
    ds_read_b128 v[182:185], v209
    ds_read_b128 v[186:189], v209 offset:1024
    ds_write_b16 v205, v2
    ds_read_b32 v192, v202 offset:256
    ds_read_b64 v[190:191], v203 offset:13440
    v_cvt_pk_bf16_f32 v134, v166, v167
    v_cvt_pk_bf16_f32 v135, v168, v169
    v_cvt_pk_bf16_f32 v136, v170, v171
    v_cvt_pk_bf16_f32 v137, v172, v173
    s_nop 1
    v_mfma_f32_16x16x32_bf16 v[36:39], v[134:137], v[174:177], v[36:39]
    v_mfma_f32_16x16x32_bf16 v[40:43], v[134:137], v[178:181], v[40:43]
    s_cmp_eq_u32 s90, 0
    s_cbranch_scc1 noep_75
    v_and_b32 v213, 15, v0
    s_mul_i32 s62, s60, 80
    v_add_u32 v213, s62, v213
    v_add_u32 v213, 64, v213
    v_cmp_gt_u32 vcc, 625, v213
    s_nop 1
    v_cndmask_b32 v214, 1.0, v72, vcc
    v_mfma_f32_16x16x16_bf16 v[158:161], v[150:151], v[60:61], 0
    v_mfma_f32_16x16x16_bf16 v[162:165], v[152:153], v[60:61], 0
    v_mfma_f32_16x16x16_bf16 v[226:229], v[154:155], v[60:61], 0
    v_lshlrev_b32 v234, 16, v70
    v_and_b32 v235, 0xffff0000, v70
    v_lshlrev_b32 v236, 16, v71
    v_and_b32 v237, 0xffff0000, v71
noep_75:
    s_waitcnt lgkmcnt(0)
    s_waitcnt vmcnt(1)
    v_mfma_f32_16x16x32_bf16 v[166:169], v[138:141], v[44:47], 0
    v_mfma_f32_16x16x32_bf16 v[170:173], v[138:141], v[48:51], 0
    v_cmp_gt_u32 vcc, s85, v195
    v_lshrrev_b32 v193, 9, v192
    v_and_or_b32 v193, v193, s92, v200
    v_cndmask_b32 v193, 1.0, v193, vcc
    buffer_load_dwordx4 v[130:133], v193, s[32:35], 0 offen
    s_cmp_gt_u32 s84, 128
    s_cbranch_scc0 sk2_76
    v_and_b32 v206, 15, v190
    v_lshl_or_b32 v206, v191, 4, v206
    v_cvt_f32_u32 v206, v206
    v_and_or_b32 v205, v190, s91, v208
    v_fma_f32 v206, v206, s93, v210
    v_fma_f32 v207, v206, v206, -0.5
    v_cndmask_b32 v206, v206, v207, s[24:25]
    v_cvt_pk_bf16_f32 v206, v206, v206
    ds_write_b16 v205, v206
    ds_read_b128 v[174:177], v209
    ds_read_b128 v[178:181], v209 offset:1024
    ds_write_b16 v205, v2
sk2_76:
    ds_read_b32 v192, v202 offset:512
    ds_read_b64 v[190:191], v203 offset:13696
    v_cvt_pk_bf16_f32 v138, v166, v167
    v_cvt_pk_bf16_f32 v139, v168, v169
    v_cvt_pk_bf16_f32 v140, v170, v171
    v_cvt_pk_bf16_f32 v141, v172, v173
    s_nop 1
    v_mfma_f32_16x16x32_bf16 v[36:39], v[138:141], v[182:185], v[36:39]
    v_mfma_f32_16x16x32_bf16 v[40:43], v[138:141], v[186:189], v[40:43]
    s_waitcnt lgkmcnt(0)
    s_cmp_gt_u32 s84, 128
    s_cbranch_scc0 sk1_77
    s_waitcnt vmcnt(2)
    v_mfma_f32_16x16x32_bf16 v[166:169], v[142:145], v[44:47], 0
    v_mfma_f32_16x16x32_bf16 v[170:173], v[142:145], v[48:51], 0
sk1_77:
    v_cmp_gt_u32 vcc, s85, v196
    v_lshrrev_b32 v193, 9, v192
    v_and_or_b32 v193, v193, s92, v200
    v_cndmask_b32 v193, 1.0, v193, vcc
    buffer_load_dwordx4 v[134:137], v193, s[32:35], 0 offen
    s_cmp_gt_u32 s84, 160
    s_cbranch_scc0 sk2_78
    v_and_b32 v206, 15, v190
    v_lshl_or_b32 v206, v191, 4, v206
    v_cvt_f32_u32 v206, v206
    v_and_or_b32 v205, v190, s91, v208
    v_fma_f32 v206, v206, s93, v210
    v_fma_f32 v207, v206, v206, -0.5
    v_cndmask_b32 v206, v206, v207, s[24:25]
    v_cvt_pk_bf16_f32 v206, v206, v206
    ds_write_b16 v205, v206
    ds_read_b128 v[182:185], v209
    ds_read_b128 v[186:189], v209 offset:1024
    ds_write_b16 v205, v2
sk2_78:
    ds_read_b32 v192, v202 offset:768
    ds_read_b64 v[190:191], v204 offset:0
    s_cmp_gt_u32 s84, 128
    s_cbranch_scc0 sk3_79
    v_cvt_pk_bf16_f32 v142, v166, v167
    v_cvt_pk_bf16_f32 v143, v168, v169
    v_cvt_pk_bf16_f32 v144, v170, v171
    v_cvt_pk_bf16_f32 v145, v172, v173
    s_nop 1
    v_mfma_f32_16x16x32_bf16 v[36:39], v[142:145], v[174:177], v[36:39]
    v_mfma_f32_16x16x32_bf16 v[40:43], v[142:145], v[178:181], v[40:43]
sk3_79:
    s_waitcnt lgkmcnt(0)
    s_cmp_gt_u32 s84, 160
    s_cbranch_scc0 sk1_80
    s_waitcnt vmcnt(3)
    v_mfma_f32_16x16x32_bf16 v[166:169], v[146:149], v[44:47], 0
    v_mfma_f32_16x16x32_bf16 v[170:173], v[146:149], v[48:51], 0
sk1_80:
    v_cmp_gt_u32 vcc, s85, v197
    v_lshrrev_b32 v193, 9, v192
    v_and_or_b32 v193, v193, s92, v200
    v_cndmask_b32 v193, 1.0, v193, vcc
    buffer_load_dwordx4 v[138:141], v193, s[32:35], 0 offen
    v_and_b32 v206, 15, v190
    v_lshl_or_b32 v206, v191, 4, v206
    v_cvt_f32_u32 v206, v206
    v_and_or_b32 v205, v190, s91, v208
    v_fma_f32 v206, v206, s93, v210
    v_fma_f32 v207, v206, v206, -0.5
    v_cndmask_b32 v206, v206, v207, s[24:25]
    v_cvt_pk_bf16_f32 v206, v206, v206
    ds_write_b16 v205, v206
    ds_read_b128 v[174:177], v209
    ds_read_b128 v[178:181], v209 offset:1024
    ds_write_b16 v205, v2
    ds_read_b32 v192, v202 offset:1024
    ds_read_b64 v[190:191], v204 offset:256
    s_cmp_gt_u32 s84, 160
    s_cbranch_scc0 sk3_81
    v_cvt_pk_bf16_f32 v146, v166, v167
    v_cvt_pk_bf16_f32 v147, v168, v169
    v_cvt_pk_bf16_f32 v148, v170, v171
    v_cvt_pk_bf16_f32 v149, v172, v173
    s_nop 1
    v_mfma_f32_16x16x32_bf16 v[36:39], v[146:149], v[182:185], v[36:39]
    v_mfma_f32_16x16x32_bf16 v[40:43], v[146:149], v[186:189], v[40:43]
sk3_81:
    v_mov_b32 v201, v202
    v_mov_b32 v203, v204
    s_mov_b32 s80, s85
    s_mov_b32 s81, s86
    s_mov_b32 s82, s87
    s_mov_b32 s83, s88
    s_mov_b32 s84, s89
    s_add_u32 s90, s90, 1
    s_cmp_le_u32 s90, 1
    s_cbranch_scc1 c_loop
    s_cmp_lg_u32 s61, 0
    s_cbranch_scc1 c_fallback
    buffer_store_dwordx2 v[62:63], v72, s[52:55], 0 offen offset:0 sc1
    buffer_store_dwordx2 v[64:65], v72, s[52:55], 0 offen offset:512 sc1
    buffer_store_dwordx2 v[66:67], v72, s[52:55], 0 offen offset:1024 sc1
    buffer_store_dwordx2 v[68:69], v72, s[52:55], 0 offen offset:1536 sc1
    v_mul_f32 v158, v158, v36
    v_mul_f32 v159, v159, v37
    v_mul_f32 v160, v160, v38
    v_mul_f32 v161, v161, v39
    v_fma_f32 v158, v162, v40, v158
    v_fma_f32 v159, v163, v41, v159
    v_fma_f32 v160, v164, v42, v160
    v_fma_f32 v161, v165, v43, v161
    v_cvt_pk_bf16_f32 v238, v158, v159
    v_cvt_pk_bf16_f32 v239, v160, v161
    s_nop 1
    v_mfma_f32_16x16x16_bf16 v[230:233], v[156:157], v[238:239], 0
    s_nop 7
    v_fma_f32 v234, v230, v226, v234
    v_fma_f32 v235, v231, v227, v235
    v_fma_f32 v236, v232, v228, v236
    v_fma_f32 v237, v233, v229, v237
    v_cvt_pk_bf16_f32 v70, v234, v235
    v_cvt_pk_bf16_f32 v71, v236, v237
    buffer_store_dwordx2 v[70:71], v214, s[52:55], 0 offen offset:2048 sc1
c_done:
    s_mov_b32 s65, 0
gd_82:
    s_memrealtime s[14:15]
    s_waitcnt lgkmcnt(0)
    s_sub_u32 s62, s14, s66
    s_cmp_ge_u32 s62, 1300
    s_cbranch_scc1 gdx_83
    s_add_u32 s65, s65, 1
    s_cmp_lt_u32 s65, 100000
    s_sleep 4
    s_cbranch_scc1 gd_82
gdx_83:
    s_endpgm
p_rare:
    v_cmp_le_u32 vcc, s63, v250
    s_cbranch_vccz pr_84
    s_mov_b64 exec, vcc
    s_waitcnt vmcnt(0)
    ds_read2_b32 v[234:235], v180 offset0:72 offset1:73
    ds_read_b32 v236, v180 offset:296
    ds_read2_b32 v[126:127], v184 offset0:18 offset1:19
    s_waitcnt lgkmcnt(0)
    v_alignbyte_b32 v237, v127, v126, v231
    v_bfi_b32 v237, s74, v237, v122
    s_add_u32 s76, s73, 25165824
    buffer_store_dwordx4 v[234:237], v123, s[56:59], s76 offen sc1
    s_mov_b64 exec, -1
pr_84:
    v_cmp_le_u32 vcc, s63, v251
    s_cbranch_vccz pr_85
    s_mov_b64 exec, vcc
    s_waitcnt vmcnt(0)
    ds_read2_b32 v[234:235], v181 offset0:72 offset1:73
    ds_read_b32 v236, v181 offset:296
    ds_read2_b32 v[126:127], v185 offset0:18 offset1:19
    s_waitcnt lgkmcnt(0)
    v_alignbyte_b32 v237, v127, v126, v231
    v_bfi_b32 v237, s74, v237, v122
    s_add_u32 s76, s73, 25427968
    buffer_store_dwordx4 v[234:237], v123, s[56:59], s76 offen sc1
    s_mov_b64 exec, -1
pr_85:
    v_cmp_le_u32 vcc, s63, v252
    s_cbranch_vccz pr_86
    s_mov_b64 exec, vcc
    s_waitcnt vmcnt(0)
    ds_read2_b32 v[234:235], v182 offset0:72 offset1:73
    ds_read_b32 v236, v182 offset:296
    ds_read2_b32 v[126:127], v186 offset0:18 offset1:19
    s_waitcnt lgkmcnt(0)
    v_alignbyte_b32 v237, v127, v126, v231
    v_bfi_b32 v237, s74, v237, v122
    s_add_u32 s76, s73, 25690112
    buffer_store_dwordx4 v[234:237], v123, s[56:59], s76 offen sc1
    s_mov_b64 exec, -1
pr_86:
    v_cmp_le_u32 vcc, s63, v253
    s_cbranch_vccz pr_87
    s_mov_b64 exec, vcc
    s_waitcnt vmcnt(0)
    ds_read2_b32 v[234:235], v183 offset0:72 offset1:73
    ds_read_b32 v236, v183 offset:296
    ds_read2_b32 v[126:127], v187 offset0:18 offset1:19
    s_waitcnt lgkmcnt(0)
    v_alignbyte_b32 v237, v127, v126, v231
    v_bfi_b32 v237, s74, v237, v122
    s_add_u32 s76, s73, 25952256
    buffer_store_dwordx4 v[234:237], v123, s[56:59], s76 offen sc1
    s_mov_b64 exec, -1
pr_87:
    s_branch p_rare_back
c_rp_z0:
    s_mov_b32 s65, 0
    s_cmp_lg_u32 s61, 0
    s_cbranch_scc1 rpt_89
rpl_88:
    s_sleep 1
    s_mov_b64 exec, vcc
    s_add_u32 s62, s94, 0
    buffer_load_dwordx4 v[126:129], v73, s[56:59], s62 offen offset:0 sc1
    s_waitcnt vmcnt(0)
    v_perm_b32 v223, v129, v129, v74
    s_nop 1
    v_or_b32_dpp v223, v223, v223 quad_perm:[1,0,3,2] row_mask:0xf bank_mask:0xf
    s_nop 1
    v_or_b32_dpp v223, v223, v223 quad_perm:[2,3,0,1] row_mask:0xf bank_mask:0xf
    v_lshlrev_b32 v224, 8, v223
    v_xad_u32 v223, v223, v224, s68
    v_cmp_le_u32 vcc, 8, v223
    s_mov_b64 exec, -1
    s_cbranch_vccz c_ok_z0
    s_add_u32 s65, s65, 1
    s_cmp_lt_u32 s65, 60000
    s_cbranch_scc1 rpl_88
rpt_89:
    s_mov_b32 s61, 1
    v_mov_b32 v213, -1
    v_cndmask_b32 v126, v126, v213, vcc
    v_cndmask_b32 v127, v127, v213, vcc
    v_cndmask_b32 v128, v128, v213, vcc
    s_branch c_ok_z0
c_rp_z1:
    s_mov_b32 s65, 0
    s_cmp_lg_u32 s61, 0
    s_cbranch_scc1 rpt_91
rpl_90:
    s_sleep 1
    s_mov_b64 exec, vcc
    s_add_u32 s62, s94, 0
    buffer_load_dwordx4 v[130:133], v73, s[56:59], s62 offen offset:1024 sc1
    s_waitcnt vmcnt(0)
    v_perm_b32 v223, v133, v133, v74
    s_nop 1
    v_or_b32_dpp v223, v223, v223 quad_perm:[1,0,3,2] row_mask:0xf bank_mask:0xf
    s_nop 1
    v_or_b32_dpp v223, v223, v223 quad_perm:[2,3,0,1] row_mask:0xf bank_mask:0xf
    v_lshlrev_b32 v224, 8, v223
    v_xad_u32 v223, v223, v224, s68
    v_cmp_le_u32 vcc, 8, v223
    s_mov_b64 exec, -1
    s_cbranch_vccz c_ok_z1
    s_add_u32 s65, s65, 1
    s_cmp_lt_u32 s65, 60000
    s_cbranch_scc1 rpl_90
rpt_91:
    s_mov_b32 s61, 1
    v_mov_b32 v213, -1
    v_cndmask_b32 v130, v130, v213, vcc
    v_cndmask_b32 v131, v131, v213, vcc
    v_cndmask_b32 v132, v132, v213, vcc
    s_branch c_ok_z1
c_rp_z2:
    s_mov_b32 s65, 0
    s_cmp_lg_u32 s61, 0
    s_cbranch_scc1 rpt_93
rpl_92:
    s_sleep 1
    s_mov_b64 exec, vcc
    s_add_u32 s62, s94, 0
    buffer_load_dwordx4 v[134:137], v73, s[56:59], s62 offen offset:2048 sc1
    s_waitcnt vmcnt(0)
    v_perm_b32 v223, v137, v137, v74
    s_nop 1
    v_or_b32_dpp v223, v223, v223 quad_perm:[1,0,3,2] row_mask:0xf bank_mask:0xf
    s_nop 1
    v_or_b32_dpp v223, v223, v223 quad_perm:[2,3,0,1] row_mask:0xf bank_mask:0xf
    v_lshlrev_b32 v224, 8, v223
    v_xad_u32 v223, v223, v224, s68
    v_cmp_le_u32 vcc, 8, v223
    s_mov_b64 exec, -1
    s_cbranch_vccz c_ok_z2
    s_add_u32 s65, s65, 1
    s_cmp_lt_u32 s65, 60000
    s_cbranch_scc1 rpl_92
rpt_93:
    s_mov_b32 s61, 1
    v_mov_b32 v213, -1
    v_cndmask_b32 v134, v134, v213, vcc
    v_cndmask_b32 v135, v135, v213, vcc
    v_cndmask_b32 v136, v136, v213, vcc
    s_branch c_ok_z2
c_rp_z3:
    s_mov_b32 s65, 0
    s_cmp_lg_u32 s61, 0
    s_cbranch_scc1 rpt_95
rpl_94:
    s_sleep 1
    s_mov_b64 exec, vcc
    s_add_u32 s62, s94, 0
    buffer_load_dwordx4 v[138:141], v73, s[56:59], s62 offen offset:3072 sc1
    s_waitcnt vmcnt(0)
    v_perm_b32 v223, v141, v141, v74
    s_nop 1
    v_or_b32_dpp v223, v223, v223 quad_perm:[1,0,3,2] row_mask:0xf bank_mask:0xf
    s_nop 1
    v_or_b32_dpp v223, v223, v223 quad_perm:[2,3,0,1] row_mask:0xf bank_mask:0xf
    v_lshlrev_b32 v224, 8, v223
    v_xad_u32 v223, v223, v224, s68
    v_cmp_le_u32 vcc, 8, v223
    s_mov_b64 exec, -1
    s_cbranch_vccz c_ok_z3
    s_add_u32 s65, s65, 1
    s_cmp_lt_u32 s65, 60000
    s_cbranch_scc1 rpl_94
rpt_95:
    s_mov_b32 s61, 1
    v_mov_b32 v213, -1
    v_cndmask_b32 v138, v138, v213, vcc
    v_cndmask_b32 v139, v139, v213, vcc
    v_cndmask_b32 v140, v140, v213, vcc
    s_branch c_ok_z3
c_rp_p0:
    s_mov_b32 s65, 0
    s_cmp_lg_u32 s61, 0
    s_cbranch_scc1 rpt_97
rpl_96:
    s_sleep 1
    s_mov_b64 exec, vcc
    s_add_u32 s62, s94, 8388608
    buffer_load_dwordx4 v[150:153], v73, s[56:59], s62 offen offset:0 sc1
    s_waitcnt vmcnt(0)
    v_perm_b32 v223, v153, v153, v74
    s_nop 1
    v_or_b32_dpp v223, v223, v223 quad_perm:[1,0,3,2] row_mask:0xf bank_mask:0xf
    s_nop 1
    v_or_b32_dpp v223, v223, v223 quad_perm:[2,3,0,1] row_mask:0xf bank_mask:0xf
    v_lshlrev_b32 v224, 8, v223
    v_xad_u32 v223, v223, v224, s68
    v_cmp_le_u32 vcc, 8, v223
    s_mov_b64 exec, -1
    s_cbranch_vccz c_ok_p0
    s_add_u32 s65, s65, 1
    s_cmp_lt_u32 s65, 60000
    s_cbranch_scc1 rpl_96
rpt_97:
    s_mov_b32 s61, 1
    v_mov_b32 v213, -1
    v_cndmask_b32 v150, v150, v213, vcc
    v_cndmask_b32 v151, v151, v213, vcc
    v_cndmask_b32 v152, v152, v213, vcc
    s_branch c_ok_p0
c_l3_0:
    s_mov_b32 s62, 25427968
    v_cmp_le_u32 vcc, s62, v152
    s_and_b64 vcc, vcc, s[26:27]
    s_cselect_b32 s62, 1, 0
    s_or_b32 s61, s61, s62
    s_lshr_b64 s[16:17], s[16:17], 7
    s_lshl_b64 s[12:13], s[16:17], 8
    s_sub_u32 s16, s12, s16
    s_subb_u32 s17, s13, s17
    s_cmp_lg_u32 s61, 0
    s_cbranch_scc1 c_l3_back_0
    s_add_u32 s62, s94, 25165824
    s_mov_b64 exec, s[16:17]
    buffer_load_dwordx4 v[226:229], v73, s[56:59], s62 offen offset:0 sc1
    s_waitcnt vmcnt(0)
    v_perm_b32 v223, v229, v229, v74
    s_nop 1
    v_or_b32_dpp v223, v223, v223 quad_perm:[1,0,3,2] row_mask:0xf bank_mask:0xf
    s_nop 1
    v_or_b32_dpp v223, v223, v223 quad_perm:[2,3,0,1] row_mask:0xf bank_mask:0xf
    v_lshlrev_b32 v224, 8, v223
    v_xad_u32 v223, v223, v224, s68
    v_cmp_le_u32 vcc, 8, v223
    s_cbranch_vccnz c_rp_t0
c_ok_t0:
    v_cmp_gt_u32 s[18:19], s69, v226
    v_cmp_gt_u32 s[20:21], s69, v227
    v_cmp_gt_u32 s[22:23], s69, v228
    v_bfe_u32 v213, v226, 8, 6
    v_bfe_u32 v214, v227, 8, 6
    v_bfe_u32 v215, v228, 8, 6
    v_lshl_or_b32 v213, v213, 1, 1
    v_lshl_or_b32 v214, v214, 1, 1
    v_lshl_or_b32 v215, v215, 1, 1
    v_lshl_add_u32 v216, v213, 2, 64
    v_lshl_add_u32 v217, v214, 2, 64
    v_lshl_add_u32 v218, v215, 2, 64
    s_mov_b64 exec, s[18:19]
    ds_add_rtn_u32 v216, v216, v3
    s_mov_b64 exec, s[20:21]
    ds_add_rtn_u32 v217, v217, v3
    s_mov_b64 exec, s[22:23]
    ds_add_rtn_u32 v218, v218, v3
    s_mov_b64 exec, -1
    v_bfe_u32 v219, v229, 0, 8
    v_bfe_u32 v220, v229, 8, 8
    v_bfe_u32 v221, v229, 16, 8
    v_mad_u32_u24 v213, v213, s71, v75
    v_mad_u32_u24 v214, v214, s71, v75
    v_mad_u32_u24 v215, v215, s71, v75
    s_waitcnt lgkmcnt(0)
    v_min_u32 v216, 192, v216
    v_min_u32 v217, 192, v217
    v_min_u32 v218, 192, v218
    v_lshl_add_u32 v213, v216, 3, v213
    v_lshl_add_u32 v214, v217, 3, v214
    v_lshl_add_u32 v215, v218, 3, v215
    s_mov_b64 exec, s[18:19]
    ds_write2_b32 v213, v226, v219 offset0:0 offset1:1
    s_mov_b64 exec, s[20:21]
    ds_write2_b32 v214, v227, v220 offset0:0 offset1:1
    s_mov_b64 exec, s[22:23]
    ds_write2_b32 v215, v228, v221 offset0:0 offset1:1
    s_mov_b64 exec, -1
    s_branch c_l3_back_0
c_rp_p1:
    s_mov_b32 s65, 0
    s_cmp_lg_u32 s61, 0
    s_cbranch_scc1 rpt_99
rpl_98:
    s_sleep 1
    s_mov_b64 exec, vcc
    s_add_u32 s62, s94, 8388608
    buffer_load_dwordx4 v[154:157], v73, s[56:59], s62 offen offset:1024 sc1
    s_waitcnt vmcnt(0)
    v_perm_b32 v223, v157, v157, v74
    s_nop 1
    v_or_b32_dpp v223, v223, v223 quad_perm:[1,0,3,2] row_mask:0xf bank_mask:0xf
    s_nop 1
    v_or_b32_dpp v223, v223, v223 quad_perm:[2,3,0,1] row_mask:0xf bank_mask:0xf
    v_lshlrev_b32 v224, 8, v223
    v_xad_u32 v223, v223, v224, s68
    v_cmp_le_u32 vcc, 8, v223
    s_mov_b64 exec, -1
    s_cbranch_vccz c_ok_p1
    s_add_u32 s65, s65, 1
    s_cmp_lt_u32 s65, 60000
    s_cbranch_scc1 rpl_98
rpt_99:
    s_mov_b32 s61, 1
    v_mov_b32 v213, -1
    v_cndmask_b32 v154, v154, v213, vcc
    v_cndmask_b32 v155, v155, v213, vcc
    v_cndmask_b32 v156, v156, v213, vcc
    s_branch c_ok_p1
c_l3_1:
    s_mov_b32 s62, 25427968
    v_cmp_le_u32 vcc, s62, v156
    s_and_b64 vcc, vcc, s[26:27]
    s_cselect_b32 s62, 1, 0
    s_or_b32 s61, s61, s62
    s_lshr_b64 s[16:17], s[16:17], 7
    s_lshl_b64 s[12:13], s[16:17], 8
    s_sub_u32 s16, s12, s16
    s_subb_u32 s17, s13, s17
    s_cmp_lg_u32 s61, 0
    s_cbranch_scc1 c_l3_back_1
    s_add_u32 s62, s94, 25165824
    s_mov_b64 exec, s[16:17]
    buffer_load_dwordx4 v[226:229], v73, s[56:59], s62 offen offset:1024 sc1
    s_waitcnt vmcnt(0)
    v_perm_b32 v223, v229, v229, v74
    s_nop 1
    v_or_b32_dpp v223, v223, v223 quad_perm:[1,0,3,2] row_mask:0xf bank_mask:0xf
    s_nop 1
    v_or_b32_dpp v223, v223, v223 quad_perm:[2,3,0,1] row_mask:0xf bank_mask:0xf
    v_lshlrev_b32 v224, 8, v223
    v_xad_u32 v223, v223, v224, s68
    v_cmp_le_u32 vcc, 8, v223
    s_cbranch_vccnz c_rp_t1
c_ok_t1:
    v_cmp_gt_u32 s[18:19], s69, v226
    v_cmp_gt_u32 s[20:21], s69, v227
    v_cmp_gt_u32 s[22:23], s69, v228
    v_bfe_u32 v213, v226, 8, 6
    v_bfe_u32 v214, v227, 8, 6
    v_bfe_u32 v215, v228, 8, 6
    v_lshl_or_b32 v213, v213, 1, 1
    v_lshl_or_b32 v214, v214, 1, 1
    v_lshl_or_b32 v215, v215, 1, 1
    v_lshl_add_u32 v216, v213, 2, 64
    v_lshl_add_u32 v217, v214, 2, 64
    v_lshl_add_u32 v218, v215, 2, 64
    s_mov_b64 exec, s[18:19]
    ds_add_rtn_u32 v216, v216, v3
    s_mov_b64 exec, s[20:21]
    ds_add_rtn_u32 v217, v217, v3
    s_mov_b64 exec, s[22:23]
    ds_add_rtn_u32 v218, v218, v3
    s_mov_b64 exec, -1
    v_bfe_u32 v219, v229, 0, 8
    v_bfe_u32 v220, v229, 8, 8
    v_bfe_u32 v221, v229, 16, 8
    v_mad_u32_u24 v213, v213, s71, v75
    v_mad_u32_u24 v214, v214, s71, v75
    v_mad_u32_u24 v215, v215, s71, v75
    s_waitcnt lgkmcnt(0)
    v_min_u32 v216, 192, v216
    v_min_u32 v217, 192, v217
    v_min_u32 v218, 192, v218
    v_lshl_add_u32 v213, v216, 3, v213
    v_lshl_add_u32 v214, v217, 3, v214
    v_lshl_add_u32 v215, v218, 3, v215
    s_mov_b64 exec, s[18:19]
    ds_write2_b32 v213, v226, v219 offset0:0 offset1:1
    s_mov_b64 exec, s[20:21]
    ds_write2_b32 v214, v227, v220 offset0:0 offset1:1
    s_mov_b64 exec, s[22:23]
    ds_write2_b32 v215, v228, v221 offset0:0 offset1:1
    s_mov_b64 exec, -1
    s_branch c_l3_back_1
c_rp_p2:
    s_mov_b32 s65, 0
    s_cmp_lg_u32 s61, 0
    s_cbranch_scc1 rpt_101
rpl_100:
    s_sleep 1
    s_mov_b64 exec, vcc
    s_add_u32 s62, s94, 8388608
    buffer_load_dwordx4 v[158:161], v73, s[56:59], s62 offen offset:2048 sc1
    s_waitcnt vmcnt(0)
    v_perm_b32 v223, v161, v161, v74
    s_nop 1
    v_or_b32_dpp v223, v223, v223 quad_perm:[1,0,3,2] row_mask:0xf bank_mask:0xf
    s_nop 1
    v_or_b32_dpp v223, v223, v223 quad_perm:[2,3,0,1] row_mask:0xf bank_mask:0xf
    v_lshlrev_b32 v224, 8, v223
    v_xad_u32 v223, v223, v224, s68
    v_cmp_le_u32 vcc, 8, v223
    s_mov_b64 exec, -1
    s_cbranch_vccz c_ok_p2
    s_add_u32 s65, s65, 1
    s_cmp_lt_u32 s65, 60000
    s_cbranch_scc1 rpl_100
rpt_101:
    s_mov_b32 s61, 1
    v_mov_b32 v213, -1
    v_cndmask_b32 v158, v158, v213, vcc
    v_cndmask_b32 v159, v159, v213, vcc
    v_cndmask_b32 v160, v160, v213, vcc
    s_branch c_ok_p2
c_l3_2:
    s_mov_b32 s62, 25427968
    v_cmp_le_u32 vcc, s62, v160
    s_and_b64 vcc, vcc, s[26:27]
    s_cselect_b32 s62, 1, 0
    s_or_b32 s61, s61, s62
    s_lshr_b64 s[16:17], s[16:17], 7
    s_lshl_b64 s[12:13], s[16:17], 8
    s_sub_u32 s16, s12, s16
    s_subb_u32 s17, s13, s17
    s_cmp_lg_u32 s61, 0
    s_cbranch_scc1 c_l3_back_2
    s_add_u32 s62, s94, 25165824
    s_mov_b64 exec, s[16:17]
    buffer_load_dwordx4 v[226:229], v73, s[56:59], s62 offen offset:2048 sc1
    s_waitcnt vmcnt(0)
    v_perm_b32 v223, v229, v229, v74
    s_nop 1
    v_or_b32_dpp v223, v223, v223 quad_perm:[1,0,3,2] row_mask:0xf bank_mask:0xf
    s_nop 1
    v_or_b32_dpp v223, v223, v223 quad_perm:[2,3,0,1] row_mask:0xf bank_mask:0xf
    v_lshlrev_b32 v224, 8, v223
    v_xad_u32 v223, v223, v224, s68
    v_cmp_le_u32 vcc, 8, v223
    s_cbranch_vccnz c_rp_t2
c_ok_t2:
    v_cmp_gt_u32 s[18:19], s69, v226
    v_cmp_gt_u32 s[20:21], s69, v227
    v_cmp_gt_u32 s[22:23], s69, v228
    v_bfe_u32 v213, v226, 8, 6
    v_bfe_u32 v214, v227, 8, 6
    v_bfe_u32 v215, v228, 8, 6
    v_lshl_or_b32 v213, v213, 1, 1
    v_lshl_or_b32 v214, v214, 1, 1
    v_lshl_or_b32 v215, v215, 1, 1
    v_lshl_add_u32 v216, v213, 2, 64
    v_lshl_add_u32 v217, v214, 2, 64
    v_lshl_add_u32 v218, v215, 2, 64
    s_mov_b64 exec, s[18:19]
    ds_add_rtn_u32 v216, v216, v3
    s_mov_b64 exec, s[20:21]
    ds_add_rtn_u32 v217, v217, v3
    s_mov_b64 exec, s[22:23]
    ds_add_rtn_u32 v218, v218, v3
    s_mov_b64 exec, -1
    v_bfe_u32 v219, v229, 0, 8
    v_bfe_u32 v220, v229, 8, 8
    v_bfe_u32 v221, v229, 16, 8
    v_mad_u32_u24 v213, v213, s71, v75
    v_mad_u32_u24 v214, v214, s71, v75
    v_mad_u32_u24 v215, v215, s71, v75
    s_waitcnt lgkmcnt(0)
    v_min_u32 v216, 192, v216
    v_min_u32 v217, 192, v217
    v_min_u32 v218, 192, v218
    v_lshl_add_u32 v213, v216, 3, v213
    v_lshl_add_u32 v214, v217, 3, v214
    v_lshl_add_u32 v215, v218, 3, v215
    s_mov_b64 exec, s[18:19]
    ds_write2_b32 v213, v226, v219 offset0:0 offset1:1
    s_mov_b64 exec, s[20:21]
    ds_write2_b32 v214, v227, v220 offset0:0 offset1:1
    s_mov_b64 exec, s[22:23]
    ds_write2_b32 v215, v228, v221 offset0:0 offset1:1
    s_mov_b64 exec, -1
    s_branch c_l3_back_2
c_rp_p3:
    s_mov_b32 s65, 0
    s_cmp_lg_u32 s61, 0
    s_cbranch_scc1 rpt_103
rpl_102:
    s_sleep 1
    s_mov_b64 exec, vcc
    s_add_u32 s62, s94, 8388608
    buffer_load_dwordx4 v[162:165], v73, s[56:59], s62 offen offset:3072 sc1
    s_waitcnt vmcnt(0)
    v_perm_b32 v223, v165, v165, v74
    s_nop 1
    v_or_b32_dpp v223, v223, v223 quad_perm:[1,0,3,2] row_mask:0xf bank_mask:0xf
    s_nop 1
    v_or_b32_dpp v223, v223, v223 quad_perm:[2,3,0,1] row_mask:0xf bank_mask:0xf
    v_lshlrev_b32 v224, 8, v223
    v_xad_u32 v223, v223, v224, s68
    v_cmp_le_u32 vcc, 8, v223
    s_mov_b64 exec, -1
    s_cbranch_vccz c_ok_p3
    s_add_u32 s65, s65, 1
    s_cmp_lt_u32 s65, 60000
    s_cbranch_scc1 rpl_102
rpt_103:
    s_mov_b32 s61, 1
    v_mov_b32 v213, -1
    v_cndmask_b32 v162, v162, v213, vcc
    v_cndmask_b32 v163, v163, v213, vcc
    v_cndmask_b32 v164, v164, v213, vcc
    s_branch c_ok_p3
c_l3_3:
    s_mov_b32 s62, 25427968
    v_cmp_le_u32 vcc, s62, v164
    s_and_b64 vcc, vcc, s[26:27]
    s_cselect_b32 s62, 1, 0
    s_or_b32 s61, s61, s62
    s_lshr_b64 s[16:17], s[16:17], 7
    s_lshl_b64 s[12:13], s[16:17], 8
    s_sub_u32 s16, s12, s16
    s_subb_u32 s17, s13, s17
    s_cmp_lg_u32 s61, 0
    s_cbranch_scc1 c_l3_back_3
    s_add_u32 s62, s94, 25165824
    s_mov_b64 exec, s[16:17]
    buffer_load_dwordx4 v[226:229], v73, s[56:59], s62 offen offset:3072 sc1
    s_waitcnt vmcnt(0)
    v_perm_b32 v223, v229, v229, v74
    s_nop 1
    v_or_b32_dpp v223, v223, v223 quad_perm:[1,0,3,2] row_mask:0xf bank_mask:0xf
    s_nop 1
    v_or_b32_dpp v223, v223, v223 quad_perm:[2,3,0,1] row_mask:0xf bank_mask:0xf
    v_lshlrev_b32 v224, 8, v223
    v_xad_u32 v223, v223, v224, s68
    v_cmp_le_u32 vcc, 8, v223
    s_cbranch_vccnz c_rp_t3
c_ok_t3:
    v_cmp_gt_u32 s[18:19], s69, v226
    v_cmp_gt_u32 s[20:21], s69, v227
    v_cmp_gt_u32 s[22:23], s69, v228
    v_bfe_u32 v213, v226, 8, 6
    v_bfe_u32 v214, v227, 8, 6
    v_bfe_u32 v215, v228, 8, 6
    v_lshl_or_b32 v213, v213, 1, 1
    v_lshl_or_b32 v214, v214, 1, 1
    v_lshl_or_b32 v215, v215, 1, 1
    v_lshl_add_u32 v216, v213, 2, 64
    v_lshl_add_u32 v217, v214, 2, 64
    v_lshl_add_u32 v218, v215, 2, 64
    s_mov_b64 exec, s[18:19]
    ds_add_rtn_u32 v216, v216, v3
    s_mov_b64 exec, s[20:21]
    ds_add_rtn_u32 v217, v217, v3
    s_mov_b64 exec, s[22:23]
    ds_add_rtn_u32 v218, v218, v3
    s_mov_b64 exec, -1
    v_bfe_u32 v219, v229, 0, 8
    v_bfe_u32 v220, v229, 8, 8
    v_bfe_u32 v221, v229, 16, 8
    v_mad_u32_u24 v213, v213, s71, v75
    v_mad_u32_u24 v214, v214, s71, v75
    v_mad_u32_u24 v215, v215, s71, v75
    s_waitcnt lgkmcnt(0)
    v_min_u32 v216, 192, v216
    v_min_u32 v217, 192, v217
    v_min_u32 v218, 192, v218
    v_lshl_add_u32 v213, v216, 3, v213
    v_lshl_add_u32 v214, v217, 3, v214
    v_lshl_add_u32 v215, v218, 3, v215
    s_mov_b64 exec, s[18:19]
    ds_write2_b32 v213, v226, v219 offset0:0 offset1:1
    s_mov_b64 exec, s[20:21]
    ds_write2_b32 v214, v227, v220 offset0:0 offset1:1
    s_mov_b64 exec, s[22:23]
    ds_write2_b32 v215, v228, v221 offset0:0 offset1:1
    s_mov_b64 exec, -1
    s_branch c_l3_back_3
c_rp_s0:
    s_mov_b32 s65, 0
    s_cmp_lg_u32 s61, 0
    s_cbranch_scc1 rpt_105
rpl_104:
    s_sleep 1
    s_mov_b64 exec, vcc
    s_add_u32 s62, s94, 16777216
    buffer_load_dwordx4 v[150:153], v73, s[56:59], s62 offen offset:0 sc1
    s_waitcnt vmcnt(0)
    v_perm_b32 v223, v153, v153, v74
    s_nop 1
    v_or_b32_dpp v223, v223, v223 quad_perm:[1,0,3,2] row_mask:0xf bank_mask:0xf
    s_nop 1
    v_or_b32_dpp v223, v223, v223 quad_perm:[2,3,0,1] row_mask:0xf bank_mask:0xf
    v_lshlrev_b32 v224, 8, v223
    v_xad_u32 v223, v223, v224, s68
    v_cmp_le_u32 vcc, 8, v223
    s_mov_b64 exec, s[4:5]
    s_cbranch_vccz c_ok_s0
    s_add_u32 s65, s65, 1
    s_cmp_lt_u32 s65, 60000
    s_cbranch_scc1 rpl_104
rpt_105:
    s_mov_b32 s61, 1
    v_mov_b32 v213, -1
    v_cndmask_b32 v150, v150, v213, vcc
    v_cndmask_b32 v151, v151, v213, vcc
    v_cndmask_b32 v152, v152, v213, vcc
    s_branch c_ok_s0
c_rp_s1:
    s_mov_b32 s65, 0
    s_cmp_lg_u32 s61, 0
    s_cbranch_scc1 rpt_107
rpl_106:
    s_sleep 1
    s_mov_b64 exec, vcc
    s_add_u32 s62, s94, 16777216
    buffer_load_dwordx4 v[154:157], v73, s[56:59], s62 offen offset:1024 sc1
    s_waitcnt vmcnt(0)
    v_perm_b32 v223, v157, v157, v74
    s_nop 1
    v_or_b32_dpp v223, v223, v223 quad_perm:[1,0,3,2] row_mask:0xf bank_mask:0xf
    s_nop 1
    v_or_b32_dpp v223, v223, v223 quad_perm:[2,3,0,1] row_mask:0xf bank_mask:0xf
    v_lshlrev_b32 v224, 8, v223
    v_xad_u32 v223, v223, v224, s68
    v_cmp_le_u32 vcc, 8, v223
    s_mov_b64 exec, s[6:7]
    s_cbranch_vccz c_ok_s1
    s_add_u32 s65, s65, 1
    s_cmp_lt_u32 s65, 60000
    s_cbranch_scc1 rpl_106
rpt_107:
    s_mov_b32 s61, 1
    v_mov_b32 v213, -1
    v_cndmask_b32 v154, v154, v213, vcc
    v_cndmask_b32 v155, v155, v213, vcc
    v_cndmask_b32 v156, v156, v213, vcc
    s_branch c_ok_s1
c_rp_s2:
    s_mov_b32 s65, 0
    s_cmp_lg_u32 s61, 0
    s_cbranch_scc1 rpt_109
rpl_108:
    s_sleep 1
    s_mov_b64 exec, vcc
    s_add_u32 s62, s94, 16777216
    buffer_load_dwordx4 v[158:161], v73, s[56:59], s62 offen offset:2048 sc1
    s_waitcnt vmcnt(0)
    v_perm_b32 v223, v161, v161, v74
    s_nop 1
    v_or_b32_dpp v223, v223, v223 quad_perm:[1,0,3,2] row_mask:0xf bank_mask:0xf
    s_nop 1
    v_or_b32_dpp v223, v223, v223 quad_perm:[2,3,0,1] row_mask:0xf bank_mask:0xf
    v_lshlrev_b32 v224, 8, v223
    v_xad_u32 v223, v223, v224, s68
    v_cmp_le_u32 vcc, 8, v223
    s_mov_b64 exec, s[8:9]
    s_cbranch_vccz c_ok_s2
    s_add_u32 s65, s65, 1
    s_cmp_lt_u32 s65, 60000
    s_cbranch_scc1 rpl_108
rpt_109:
    s_mov_b32 s61, 1
    v_mov_b32 v213, -1
    v_cndmask_b32 v158, v158, v213, vcc
    v_cndmask_b32 v159, v159, v213, vcc
    v_cndmask_b32 v160, v160, v213, vcc
    s_branch c_ok_s2
c_rp_s3:
    s_mov_b32 s65, 0
    s_cmp_lg_u32 s61, 0
    s_cbranch_scc1 rpt_111
rpl_110:
    s_sleep 1
    s_mov_b64 exec, vcc
    s_add_u32 s62, s94, 16777216
    buffer_load_dwordx4 v[162:165], v73, s[56:59], s62 offen offset:3072 sc1
    s_waitcnt vmcnt(0)
    v_perm_b32 v223, v165, v165, v74
    s_nop 1
    v_or_b32_dpp v223, v223, v223 quad_perm:[1,0,3,2] row_mask:0xf bank_mask:0xf
    s_nop 1
    v_or_b32_dpp v223, v223, v223 quad_perm:[2,3,0,1] row_mask:0xf bank_mask:0xf
    v_lshlrev_b32 v224, 8, v223
    v_xad_u32 v223, v223, v224, s68
    v_cmp_le_u32 vcc, 8, v223
    s_mov_b64 exec, s[10:11]
    s_cbranch_vccz c_ok_s3
    s_add_u32 s65, s65, 1
    s_cmp_lt_u32 s65, 60000
    s_cbranch_scc1 rpl_110
rpt_111:
    s_mov_b32 s61, 1
    v_mov_b32 v213, -1
    v_cndmask_b32 v162, v162, v213, vcc
    v_cndmask_b32 v163, v163, v213, vcc
    v_cndmask_b32 v164, v164, v213, vcc
    s_branch c_ok_s3
c_fallback:
    s_waitcnt vmcnt(0) lgkmcnt(0)
    global_store_dword v2, v3, s[28:29] offset:16
    v_mov_b32 v4, 0
    v_mov_b32 v5, 0
    v_mov_b32 v6, 0
    v_mov_b32 v7, 0
    v_mov_b32 v8, 0
    v_mov_b32 v9, 0
    v_mov_b32 v10, 0
    v_mov_b32 v11, 0
    v_mov_b32 v12, 0
    v_mov_b32 v13, 0
    v_mov_b32 v14, 0
    v_mov_b32 v15, 0
    v_mov_b32 v16, 0
    v_mov_b32 v17, 0
    v_mov_b32 v18, 0
    v_mov_b32 v19, 0
    v_mov_b32 v20, 0
    v_mov_b32 v21, 0
    v_mov_b32 v22, 0
    v_mov_b32 v23, 0
    v_mov_b32 v24, 0
    v_mov_b32 v25, 0
    v_mov_b32 v26, 0
    v_mov_b32 v27, 0
    v_mov_b32 v28, 0
    v_mov_b32 v29, 0
    v_mov_b32 v30, 0
    v_mov_b32 v31, 0
    v_mov_b32 v32, 0
    v_mov_b32 v33, 0
    v_mov_b32 v34, 0
    v_mov_b32 v35, 0
    v_mov_b32 v36, 0
    v_mov_b32 v37, 0
    v_mov_b32 v38, 0
    v_mov_b32 v39, 0
    v_mov_b32 v40, 0
    v_mov_b32 v41, 0
    v_mov_b32 v42, 0
    v_mov_b32 v43, 0
    s_movk_i32 s90, 80
    s_cmp_eq_u32 s60, 7
    s_cselect_b32 s90, 65, s90
    s_mov_b32 s94, 0
    v_lshlrev_b32 v192, 4, v0
    v_and_b32 v205, 15, v0
    v_mov_b32 v175, 0
    v_mov_b32 v179, 0
    v_mov_b32 v176, 0
    v_mov_b32 v180, 0
    v_mov_b32 v177, 0
    v_mov_b32 v181, 0
    v_cmp_eq_u32 s[8:9], 0, v194
c_fb_chunk:
    buffer_load_dwordx4 v[162:165], v192, s[40:43], s94 offen
    s_waitcnt vmcnt(0)
    v_subrev_u32 v162, s67, v162
    v_cmp_gt_u32 s[4:5], s90, v162
c_fb_h0:
    s_cmp_eq_u64 s[4:5], 0
    s_cbranch_scc1 c_fb_d0
    s_ff1_i32_b64 s65, s[4:5]
    s_bitset0_b64 s[4:5], s65
    s_nop 3
    v_readlane_b32 s6, v162, s65
    s_lshl_b32 s7, s65, 4
    s_add_u32 s7, s7, s94
    s_add_u32 s7, s7, 0
    v_mov_b32 v193, s7
    v_lshrrev_b32 v206, 1, v193
    buffer_load_dword v190, v193, s[36:39], 0 offen
    buffer_load_ushort v191, v206, s[48:51], 0 offen
    s_waitcnt vmcnt(0)
    v_lshl_or_b32 v193, v190, 5, v200
    v_cndmask_b32 v193, 1.0, v193, s[8:9]
    buffer_load_dwordx4 v[126:129], v193, s[32:35], 0 offen
    v_lshlrev_b32 v191, 16, v191
    v_mul_f32 v191, 0x3e22f983, v191
    v_fract_f32 v191, v191
    v_cos_f32 v191, v191
    s_and_b32 s62, s6, 15
    v_cmp_eq_u32 s[10:11], s62, v0
    v_fma_f32 v190, v191, v191, -0.5
    v_cvt_pk_bf16_f32 v190, v191, v190
    v_and_b32 v191, 0xffff, v190
    v_lshrrev_b32 v190, 16, v190
    v_cndmask_b32 v174, 0, v191, s[10:11]
    v_cndmask_b32 v178, 0, v190, s[10:11]
    s_waitcnt vmcnt(0)
    v_mfma_f32_16x16x32_bf16 v[166:169], v[126:129], v[44:47], 0
    v_mfma_f32_16x16x32_bf16 v[170:173], v[126:129], v[48:51], 0
    s_nop 6
    v_cvt_pk_bf16_f32 v126, v166, v167
    v_cvt_pk_bf16_f32 v127, v168, v169
    v_cvt_pk_bf16_f32 v128, v170, v171
    v_cvt_pk_bf16_f32 v129, v172, v173
    s_lshr_b32 s62, s6, 4
    s_cmp_lg_u32 s62, 0
    s_cbranch_scc1 fbj_112
    v_mfma_f32_16x16x32_bf16 v[4:7], v[126:129], v[174:177], v[4:7]
    v_mfma_f32_16x16x32_bf16 v[8:11], v[126:129], v[178:181], v[8:11]
fbj_112:
    s_cmp_lg_u32 s62, 1
    s_cbranch_scc1 fbj_113
    v_mfma_f32_16x16x32_bf16 v[12:15], v[126:129], v[174:177], v[12:15]
    v_mfma_f32_16x16x32_bf16 v[16:19], v[126:129], v[178:181], v[16:19]
fbj_113:
    s_cmp_lg_u32 s62, 2
    s_cbranch_scc1 fbj_114
    v_mfma_f32_16x16x32_bf16 v[20:23], v[126:129], v[174:177], v[20:23]
    v_mfma_f32_16x16x32_bf16 v[24:27], v[126:129], v[178:181], v[24:27]
fbj_114:
    s_cmp_lg_u32 s62, 3
    s_cbranch_scc1 fbj_115
    v_mfma_f32_16x16x32_bf16 v[28:31], v[126:129], v[174:177], v[28:31]
    v_mfma_f32_16x16x32_bf16 v[32:35], v[126:129], v[178:181], v[32:35]
fbj_115:
    s_cmp_lg_u32 s62, 4
    s_cbranch_scc1 fbj_116
    v_mfma_f32_16x16x32_bf16 v[36:39], v[126:129], v[174:177], v[36:39]
    v_mfma_f32_16x16x32_bf16 v[40:43], v[126:129], v[178:181], v[40:43]
fbj_116:
    s_branch c_fb_h0
c_fb_d0:
    v_subrev_u32 v163, s67, v163
    v_cmp_gt_u32 s[4:5], s90, v163
c_fb_h1:
    s_cmp_eq_u64 s[4:5], 0
    s_cbranch_scc1 c_fb_d1
    s_ff1_i32_b64 s65, s[4:5]
    s_bitset0_b64 s[4:5], s65
    s_nop 3
    v_readlane_b32 s6, v163, s65
    s_lshl_b32 s7, s65, 4
    s_add_u32 s7, s7, s94
    s_add_u32 s7, s7, 4
    v_mov_b32 v193, s7
    v_lshrrev_b32 v206, 1, v193
    buffer_load_dword v190, v193, s[36:39], 0 offen
    buffer_load_ushort v191, v206, s[48:51], 0 offen
    s_waitcnt vmcnt(0)
    v_lshl_or_b32 v193, v190, 5, v200
    v_cndmask_b32 v193, 1.0, v193, s[8:9]
    buffer_load_dwordx4 v[126:129], v193, s[32:35], 0 offen
    v_lshlrev_b32 v191, 16, v191
    v_mul_f32 v191, 0x3e22f983, v191
    v_fract_f32 v191, v191
    v_cos_f32 v191, v191
    s_and_b32 s62, s6, 15
    v_cmp_eq_u32 s[10:11], s62, v0
    v_fma_f32 v190, v191, v191, -0.5
    v_cvt_pk_bf16_f32 v190, v191, v190
    v_and_b32 v191, 0xffff, v190
    v_lshrrev_b32 v190, 16, v190
    v_cndmask_b32 v174, 0, v191, s[10:11]
    v_cndmask_b32 v178, 0, v190, s[10:11]
    s_waitcnt vmcnt(0)
    v_mfma_f32_16x16x32_bf16 v[166:169], v[126:129], v[44:47], 0
    v_mfma_f32_16x16x32_bf16 v[170:173], v[126:129], v[48:51], 0
    s_nop 6
    v_cvt_pk_bf16_f32 v126, v166, v167
    v_cvt_pk_bf16_f32 v127, v168, v169
    v_cvt_pk_bf16_f32 v128, v170, v171
    v_cvt_pk_bf16_f32 v129, v172, v173
    s_lshr_b32 s62, s6, 4
    s_cmp_lg_u32 s62, 0
    s_cbranch_scc1 fbj_117
    v_mfma_f32_16x16x32_bf16 v[4:7], v[126:129], v[174:177], v[4:7]
    v_mfma_f32_16x16x32_bf16 v[8:11], v[126:129], v[178:181], v[8:11]
fbj_117:
    s_cmp_lg_u32 s62, 1
    s_cbranch_scc1 fbj_118
    v_mfma_f32_16x16x32_bf16 v[12:15], v[126:129], v[174:177], v[12:15]
    v_mfma_f32_16x16x32_bf16 v[16:19], v[126:129], v[178:181], v[16:19]
fbj_118:
    s_cmp_lg_u32 s62, 2
    s_cbranch_scc1 fbj_119
    v_mfma_f32_16x16x32_bf16 v[20:23], v[126:129], v[174:177], v[20:23]
    v_mfma_f32_16x16x32_bf16 v[24:27], v[126:129], v[178:181], v[24:27]
fbj_119:
    s_cmp_lg_u32 s62, 3
    s_cbranch_scc1 fbj_120
    v_mfma_f32_16x16x32_bf16 v[28:31], v[126:129], v[174:177], v[28:31]
    v_mfma_f32_16x16x32_bf16 v[32:35], v[126:129], v[178:181], v[32:35]
fbj_120:
    s_cmp_lg_u32 s62, 4
    s_cbranch_scc1 fbj_121
    v_mfma_f32_16x16x32_bf16 v[36:39], v[126:129], v[174:177], v[36:39]
    v_mfma_f32_16x16x32_bf16 v[40:43], v[126:129], v[178:181], v[40:43]
fbj_121:
    s_branch c_fb_h1
c_fb_d1:
    v_subrev_u32 v164, s67, v164
    v_cmp_gt_u32 s[4:5], s90, v164
c_fb_h2:
    s_cmp_eq_u64 s[4:5], 0
    s_cbranch_scc1 c_fb_d2
    s_ff1_i32_b64 s65, s[4:5]
    s_bitset0_b64 s[4:5], s65
    s_nop 3
    v_readlane_b32 s6, v164, s65
    s_lshl_b32 s7, s65, 4
    s_add_u32 s7, s7, s94
    s_add_u32 s7, s7, 8
    v_mov_b32 v193, s7
    v_lshrrev_b32 v206, 1, v193
    buffer_load_dword v190, v193, s[36:39], 0 offen
    buffer_load_ushort v191, v206, s[48:51], 0 offen
    s_waitcnt vmcnt(0)
    v_lshl_or_b32 v193, v190, 5, v200
    v_cndmask_b32 v193, 1.0, v193, s[8:9]
    buffer_load_dwordx4 v[126:129], v193, s[32:35], 0 offen
    v_lshlrev_b32 v191, 16, v191
    v_mul_f32 v191, 0x3e22f983, v191
    v_fract_f32 v191, v191
    v_cos_f32 v191, v191
    s_and_b32 s62, s6, 15
    v_cmp_eq_u32 s[10:11], s62, v0
    v_fma_f32 v190, v191, v191, -0.5
    v_cvt_pk_bf16_f32 v190, v191, v190
    v_and_b32 v191, 0xffff, v190
    v_lshrrev_b32 v190, 16, v190
    v_cndmask_b32 v174, 0, v191, s[10:11]
    v_cndmask_b32 v178, 0, v190, s[10:11]
    s_waitcnt vmcnt(0)
    v_mfma_f32_16x16x32_bf16 v[166:169], v[126:129], v[44:47], 0
    v_mfma_f32_16x16x32_bf16 v[170:173], v[126:129], v[48:51], 0
    s_nop 6
    v_cvt_pk_bf16_f32 v126, v166, v167
    v_cvt_pk_bf16_f32 v127, v168, v169
    v_cvt_pk_bf16_f32 v128, v170, v171
    v_cvt_pk_bf16_f32 v129, v172, v173
    s_lshr_b32 s62, s6, 4
    s_cmp_lg_u32 s62, 0
    s_cbranch_scc1 fbj_122
    v_mfma_f32_16x16x32_bf16 v[4:7], v[126:129], v[174:177], v[4:7]
    v_mfma_f32_16x16x32_bf16 v[8:11], v[126:129], v[178:181], v[8:11]
fbj_122:
    s_cmp_lg_u32 s62, 1
    s_cbranch_scc1 fbj_123
    v_mfma_f32_16x16x32_bf16 v[12:15], v[126:129], v[174:177], v[12:15]
    v_mfma_f32_16x16x32_bf16 v[16:19], v[126:129], v[178:181], v[16:19]
fbj_123:
    s_cmp_lg_u32 s62, 2
    s_cbranch_scc1 fbj_124
    v_mfma_f32_16x16x32_bf16 v[20:23], v[126:129], v[174:177], v[20:23]
    v_mfma_f32_16x16x32_bf16 v[24:27], v[126:129], v[178:181], v[24:27]
fbj_124:
    s_cmp_lg_u32 s62, 3
    s_cbranch_scc1 fbj_125
    v_mfma_f32_16x16x32_bf16 v[28:31], v[126:129], v[174:177], v[28:31]
    v_mfma_f32_16x16x32_bf16 v[32:35], v[126:129], v[178:181], v[32:35]
fbj_125:
    s_cmp_lg_u32 s62, 4
    s_cbranch_scc1 fbj_126
    v_mfma_f32_16x16x32_bf16 v[36:39], v[126:129], v[174:177], v[36:39]
    v_mfma_f32_16x16x32_bf16 v[40:43], v[126:129], v[178:181], v[40:43]
fbj_126:
    s_branch c_fb_h2
c_fb_d2:
    v_subrev_u32 v165, s67, v165
    v_cmp_gt_u32 s[4:5], s90, v165
c_fb_h3:
    s_cmp_eq_u64 s[4:5], 0
    s_cbranch_scc1 c_fb_d3
    s_ff1_i32_b64 s65, s[4:5]
    s_bitset0_b64 s[4:5], s65
    s_nop 3
    v_readlane_b32 s6, v165, s65
    s_lshl_b32 s7, s65, 4
    s_add_u32 s7, s7, s94
    s_add_u32 s7, s7, 12
    v_mov_b32 v193, s7
    v_lshrrev_b32 v206, 1, v193
    buffer_load_dword v190, v193, s[36:39], 0 offen
    buffer_load_ushort v191, v206, s[48:51], 0 offen
    s_waitcnt vmcnt(0)
    v_lshl_or_b32 v193, v190, 5, v200
    v_cndmask_b32 v193, 1.0, v193, s[8:9]
    buffer_load_dwordx4 v[126:129], v193, s[32:35], 0 offen
    v_lshlrev_b32 v191, 16, v191
    v_mul_f32 v191, 0x3e22f983, v191
    v_fract_f32 v191, v191
    v_cos_f32 v191, v191
    s_and_b32 s62, s6, 15
    v_cmp_eq_u32 s[10:11], s62, v0
    v_fma_f32 v190, v191, v191, -0.5
    v_cvt_pk_bf16_f32 v190, v191, v190
    v_and_b32 v191, 0xffff, v190
    v_lshrrev_b32 v190, 16, v190
    v_cndmask_b32 v174, 0, v191, s[10:11]
    v_cndmask_b32 v178, 0, v190, s[10:11]
    s_waitcnt vmcnt(0)
    v_mfma_f32_16x16x32_bf16 v[166:169], v[126:129], v[44:47], 0
    v_mfma_f32_16x16x32_bf16 v[170:173], v[126:129], v[48:51], 0
    s_nop 6
    v_cvt_pk_bf16_f32 v126, v166, v167
    v_cvt_pk_bf16_f32 v127, v168, v169
    v_cvt_pk_bf16_f32 v128, v170, v171
    v_cvt_pk_bf16_f32 v129, v172, v173
    s_lshr_b32 s62, s6, 4
    s_cmp_lg_u32 s62, 0
    s_cbranch_scc1 fbj_127
    v_mfma_f32_16x16x32_bf16 v[4:7], v[126:129], v[174:177], v[4:7]
    v_mfma_f32_16x16x32_bf16 v[8:11], v[126:129], v[178:181], v[8:11]
fbj_127:
    s_cmp_lg_u32 s62, 1
    s_cbranch_scc1 fbj_128
    v_mfma_f32_16x16x32_bf16 v[12:15], v[126:129], v[174:177], v[12:15]
    v_mfma_f32_16x16x32_bf16 v[16:19], v[126:129], v[178:181], v[16:19]
fbj_128:
    s_cmp_lg_u32 s62, 2
    s_cbranch_scc1 fbj_129
    v_mfma_f32_16x16x32_bf16 v[20:23], v[126:129], v[174:177], v[20:23]
    v_mfma_f32_16x16x32_bf16 v[24:27], v[126:129], v[178:181], v[24:27]
fbj_129:
    s_cmp_lg_u32 s62, 3
    s_cbranch_scc1 fbj_130
    v_mfma_f32_16x16x32_bf16 v[28:31], v[126:129], v[174:177], v[28:31]
    v_mfma_f32_16x16x32_bf16 v[32:35], v[126:129], v[178:181], v[32:35]
fbj_130:
    s_cmp_lg_u32 s62, 4
    s_cbranch_scc1 fbj_131
    v_mfma_f32_16x16x32_bf16 v[36:39], v[126:129], v[174:177], v[36:39]
    v_mfma_f32_16x16x32_bf16 v[40:43], v[126:129], v[178:181], v[40:43]
fbj_131:
    s_branch c_fb_h3
c_fb_d3:
    s_add_u32 s94, s94, 1024
    s_cmp_lt_u32 s94, 10240000
    s_cbranch_scc1 c_fb_chunk
    s_branch c_fb_back
c_fb_back:
    buffer_load_dwordx2 v[62:63], v72, s[32:35], 0 offen offset:0
    buffer_load_dwordx2 v[64:65], v72, s[32:35], 0 offen offset:512
    buffer_load_dwordx2 v[66:67], v72, s[32:35], 0 offen offset:1024
    buffer_load_dwordx2 v[68:69], v72, s[32:35], 0 offen offset:1536
    buffer_load_dwordx2 v[70:71], v72, s[32:35], 0 offen offset:2048
    v_lshlrev_b32 v192, 3, v0
    ds_read_b64 v[150:151], v192 offset:1024
    ds_read_b64 v[152:153], v192 offset:1536
    ds_read_b64 v[154:155], v192 offset:2048
    ds_read_b64 v[156:157], v192 offset:2560
    s_waitcnt vmcnt(0) lgkmcnt(0)
    v_and_b32 v213, 15, v0
    s_mul_i32 s62, s60, 80
    v_add_u32 v213, s62, v213
    v_add_u32 v213, 64, v213
    v_cmp_gt_u32 vcc, 625, v213
    s_nop 1
    v_cndmask_b32 v214, 1.0, v72, vcc
    v_mfma_f32_16x16x16_bf16 v[126:129], v[150:151], v[52:53], 0
    v_mfma_f32_16x16x16_bf16 v[134:137], v[152:153], v[52:53], 0
    v_mfma_f32_16x16x16_bf16 v[142:145], v[154:155], v[52:53], 0
    v_mfma_f32_16x16x16_bf16 v[130:133], v[150:151], v[54:55], 0
    v_mfma_f32_16x16x16_bf16 v[138:141], v[152:153], v[54:55], 0
    v_mfma_f32_16x16x16_bf16 v[146:149], v[154:155], v[54:55], 0
    v_lshlrev_b32 v178, 16, v62
    v_and_b32 v179, 0xffff0000, v62
    v_lshlrev_b32 v180, 16, v63
    v_and_b32 v181, 0xffff0000, v63
    v_mul_f32 v126, v126, v4
    v_mul_f32 v127, v127, v5
    v_mul_f32 v128, v128, v6
    v_mul_f32 v129, v129, v7
    v_fma_f32 v126, v134, v8, v126
    v_fma_f32 v127, v135, v9, v127
    v_fma_f32 v128, v136, v10, v128
    v_fma_f32 v129, v137, v11, v129
    v_cvt_pk_bf16_f32 v174, v126, v127
    v_cvt_pk_bf16_f32 v175, v128, v129
    s_nop 1
    v_mfma_f32_16x16x16_bf16 v[166:169], v[156:157], v[174:175], 0
    s_nop 7
    v_fma_f32 v178, v166, v142, v178
    v_fma_f32 v179, v167, v143, v179
    v_fma_f32 v180, v168, v144, v180
    v_fma_f32 v181, v169, v145, v181
    v_cvt_pk_bf16_f32 v186, v178, v179
    v_cvt_pk_bf16_f32 v187, v180, v181
    buffer_store_dwordx2 v[186:187], v72, s[52:55], 0 offen offset:0 sc1
    v_mfma_f32_16x16x16_bf16 v[126:129], v[150:151], v[56:57], 0
    v_mfma_f32_16x16x16_bf16 v[134:137], v[152:153], v[56:57], 0
    v_mfma_f32_16x16x16_bf16 v[142:145], v[154:155], v[56:57], 0
    v_lshlrev_b32 v182, 16, v64
    v_and_b32 v183, 0xffff0000, v64
    v_lshlrev_b32 v184, 16, v65
    v_and_b32 v185, 0xffff0000, v65
    v_mul_f32 v130, v130, v12
    v_mul_f32 v131, v131, v13
    v_mul_f32 v132, v132, v14
    v_mul_f32 v133, v133, v15
    v_fma_f32 v130, v138, v16, v130
    v_fma_f32 v131, v139, v17, v131
    v_fma_f32 v132, v140, v18, v132
    v_fma_f32 v133, v141, v19, v133
    v_cvt_pk_bf16_f32 v176, v130, v131
    v_cvt_pk_bf16_f32 v177, v132, v133
    s_nop 1
    v_mfma_f32_16x16x16_bf16 v[170:173], v[156:157], v[176:177], 0
    s_nop 7
    v_fma_f32 v182, v170, v146, v182
    v_fma_f32 v183, v171, v147, v183
    v_fma_f32 v184, v172, v148, v184
    v_fma_f32 v185, v173, v149, v185
    v_cvt_pk_bf16_f32 v188, v182, v183
    v_cvt_pk_bf16_f32 v189, v184, v185
    buffer_store_dwordx2 v[188:189], v72, s[52:55], 0 offen offset:512 sc1
    v_mfma_f32_16x16x16_bf16 v[130:133], v[150:151], v[58:59], 0
    v_mfma_f32_16x16x16_bf16 v[138:141], v[152:153], v[58:59], 0
    v_mfma_f32_16x16x16_bf16 v[146:149], v[154:155], v[58:59], 0
    v_lshlrev_b32 v178, 16, v66
    v_and_b32 v179, 0xffff0000, v66
    v_lshlrev_b32 v180, 16, v67
    v_and_b32 v181, 0xffff0000, v67
    v_mul_f32 v126, v126, v20
    v_mul_f32 v127, v127, v21
    v_mul_f32 v128, v128, v22
    v_mul_f32 v129, v129, v23
    v_fma_f32 v126, v134, v24, v126
    v_fma_f32 v127, v135, v25, v127
    v_fma_f32 v128, v136, v26, v128
    v_fma_f32 v129, v137, v27, v129
    v_cvt_pk_bf16_f32 v174, v126, v127
    v_cvt_pk_bf16_f32 v175, v128, v129
    s_nop 1
    v_mfma_f32_16x16x16_bf16 v[166:169], v[156:157], v[174:175], 0
    s_nop 7
    v_fma_f32 v178, v166, v142, v178
    v_fma_f32 v179, v167, v143, v179
    v_fma_f32 v180, v168, v144, v180
    v_fma_f32 v181, v169, v145, v181
    v_cvt_pk_bf16_f32 v186, v178, v179
    v_cvt_pk_bf16_f32 v187, v180, v181
    buffer_store_dwordx2 v[186:187], v72, s[52:55], 0 offen offset:1024 sc1
    v_mfma_f32_16x16x16_bf16 v[126:129], v[150:151], v[60:61], 0
    v_mfma_f32_16x16x16_bf16 v[134:137], v[152:153], v[60:61], 0
    v_mfma_f32_16x16x16_bf16 v[142:145], v[154:155], v[60:61], 0
    v_lshlrev_b32 v182, 16, v68
    v_and_b32 v183, 0xffff0000, v68
    v_lshlrev_b32 v184, 16, v69
    v_and_b32 v185, 0xffff0000, v69
    v_mul_f32 v130, v130, v28
    v_mul_f32 v131, v131, v29
    v_mul_f32 v132, v132, v30
    v_mul_f32 v133, v133, v31
    v_fma_f32 v130, v138, v32, v130
    v_fma_f32 v131, v139, v33, v131
    v_fma_f32 v132, v140, v34, v132
    v_fma_f32 v133, v141, v35, v133
    v_cvt_pk_bf16_f32 v176, v130, v131
    v_cvt_pk_bf16_f32 v177, v132, v133
    s_nop 1
    v_mfma_f32_16x16x16_bf16 v[170:173], v[156:157], v[176:177], 0
    s_nop 7
    v_fma_f32 v182, v170, v146, v182
    v_fma_f32 v183, v171, v147, v183
    v_fma_f32 v184, v172, v148, v184
    v_fma_f32 v185, v173, v149, v185
    v_cvt_pk_bf16_f32 v188, v182, v183
    v_cvt_pk_bf16_f32 v189, v184, v185
    buffer_store_dwordx2 v[188:189], v72, s[52:55], 0 offen offset:1536 sc1
    v_lshlrev_b32 v178, 16, v70
    v_and_b32 v179, 0xffff0000, v70
    v_lshlrev_b32 v180, 16, v71
    v_and_b32 v181, 0xffff0000, v71
    v_mul_f32 v126, v126, v36
    v_mul_f32 v127, v127, v37
    v_mul_f32 v128, v128, v38
    v_mul_f32 v129, v129, v39
    v_fma_f32 v126, v134, v40, v126
    v_fma_f32 v127, v135, v41, v127
    v_fma_f32 v128, v136, v42, v128
    v_fma_f32 v129, v137, v43, v129
    v_cvt_pk_bf16_f32 v174, v126, v127
    v_cvt_pk_bf16_f32 v175, v128, v129
    s_nop 1
    v_mfma_f32_16x16x16_bf16 v[166:169], v[156:157], v[174:175], 0
    s_nop 7
    v_fma_f32 v178, v166, v142, v178
    v_fma_f32 v179, v167, v143, v179
    v_fma_f32 v180, v168, v144, v180
    v_fma_f32 v181, v169, v145, v181
    v_cvt_pk_bf16_f32 v186, v178, v179
    v_cvt_pk_bf16_f32 v187, v180, v181
    buffer_store_dwordx2 v[186:187], v214, s[52:55], 0 offen offset:2048 sc1
    s_branch c_done
c_rp_t0:
    s_mov_b32 s65, 0
    s_cmp_lg_u32 s61, 0
    s_cbranch_scc1 rpt_133
rpl_132:
    s_sleep 1
    s_mov_b64 exec, vcc
    s_add_u32 s62, s94, 25165824
    buffer_load_dwordx4 v[226:229], v73, s[56:59], s62 offen offset:0 sc1
    s_waitcnt vmcnt(0)
    v_perm_b32 v223, v229, v229, v74
    s_nop 1
    v_or_b32_dpp v223, v223, v223 quad_perm:[1,0,3,2] row_mask:0xf bank_mask:0xf
    s_nop 1
    v_or_b32_dpp v223, v223, v223 quad_perm:[2,3,0,1] row_mask:0xf bank_mask:0xf
    v_lshlrev_b32 v224, 8, v223
    v_xad_u32 v223, v223, v224, s68
    v_cmp_le_u32 vcc, 8, v223
    s_mov_b64 exec, s[16:17]
    s_cbranch_vccz c_ok_t0
    s_add_u32 s65, s65, 1
    s_cmp_lt_u32 s65, 60000
    s_cbranch_scc1 rpl_132
rpt_133:
    s_mov_b32 s61, 1
    v_mov_b32 v213, -1
    v_cndmask_b32 v226, v226, v213, vcc
    v_cndmask_b32 v227, v227, v213, vcc
    v_cndmask_b32 v228, v228, v213, vcc
    s_branch c_ok_t0
c_rp_t1:
    s_mov_b32 s65, 0
    s_cmp_lg_u32 s61, 0
    s_cbranch_scc1 rpt_135
rpl_134:
    s_sleep 1
    s_mov_b64 exec, vcc
    s_add_u32 s62, s94, 25165824
    buffer_load_dwordx4 v[226:229], v73, s[56:59], s62 offen offset:1024 sc1
    s_waitcnt vmcnt(0)
    v_perm_b32 v223, v229, v229, v74
    s_nop 1
    v_or_b32_dpp v223, v223, v223 quad_perm:[1,0,3,2] row_mask:0xf bank_mask:0xf
    s_nop 1
    v_or_b32_dpp v223, v223, v223 quad_perm:[2,3,0,1] row_mask:0xf bank_mask:0xf
    v_lshlrev_b32 v224, 8, v223
    v_xad_u32 v223, v223, v224, s68
    v_cmp_le_u32 vcc, 8, v223
    s_mov_b64 exec, s[16:17]
    s_cbranch_vccz c_ok_t1
    s_add_u32 s65, s65, 1
    s_cmp_lt_u32 s65, 60000
    s_cbranch_scc1 rpl_134
rpt_135:
    s_mov_b32 s61, 1
    v_mov_b32 v213, -1
    v_cndmask_b32 v226, v226, v213, vcc
    v_cndmask_b32 v227, v227, v213, vcc
    v_cndmask_b32 v228, v228, v213, vcc
    s_branch c_ok_t1
c_rp_t2:
    s_mov_b32 s65, 0
    s_cmp_lg_u32 s61, 0
    s_cbranch_scc1 rpt_137
rpl_136:
    s_sleep 1
    s_mov_b64 exec, vcc
    s_add_u32 s62, s94, 25165824
    buffer_load_dwordx4 v[226:229], v73, s[56:59], s62 offen offset:2048 sc1
    s_waitcnt vmcnt(0)
    v_perm_b32 v223, v229, v229, v74
    s_nop 1
    v_or_b32_dpp v223, v223, v223 quad_perm:[1,0,3,2] row_mask:0xf bank_mask:0xf
    s_nop 1
    v_or_b32_dpp v223, v223, v223 quad_perm:[2,3,0,1] row_mask:0xf bank_mask:0xf
    v_lshlrev_b32 v224, 8, v223
    v_xad_u32 v223, v223, v224, s68
    v_cmp_le_u32 vcc, 8, v223
    s_mov_b64 exec, s[16:17]
    s_cbranch_vccz c_ok_t2
    s_add_u32 s65, s65, 1
    s_cmp_lt_u32 s65, 60000
    s_cbranch_scc1 rpl_136
rpt_137:
    s_mov_b32 s61, 1
    v_mov_b32 v213, -1
    v_cndmask_b32 v226, v226, v213, vcc
    v_cndmask_b32 v227, v227, v213, vcc
    v_cndmask_b32 v228, v228, v213, vcc
    s_branch c_ok_t2
c_rp_t3:
    s_mov_b32 s65, 0
    s_cmp_lg_u32 s61, 0
    s_cbranch_scc1 rpt_139
rpl_138:
    s_sleep 1
    s_mov_b64 exec, vcc
    s_add_u32 s62, s94, 25165824
    buffer_load_dwordx4 v[226:229], v73, s[56:59], s62 offen offset:3072 sc1
    s_waitcnt vmcnt(0)
    v_perm_b32 v223, v229, v229, v74
    s_nop 1
    v_or_b32_dpp v223, v223, v223 quad_perm:[1,0,3,2] row_mask:0xf bank_mask:0xf
    s_nop 1
    v_or_b32_dpp v223, v223, v223 quad_perm:[2,3,0,1] row_mask:0xf bank_mask:0xf
    v_lshlrev_b32 v224, 8, v223
    v_xad_u32 v223, v223, v224, s68
    v_cmp_le_u32 vcc, 8, v223
    s_mov_b64 exec, s[16:17]
    s_cbranch_vccz c_ok_t3
    s_add_u32 s65, s65, 1
    s_cmp_lt_u32 s65, 60000
    s_cbranch_scc1 rpl_138
rpt_139:
    s_mov_b32 s61, 1
    v_mov_b32 v213, -1
    v_cndmask_b32 v226, v226, v213, vcc
    v_cndmask_b32 v227, v227, v213, vcc
    v_cndmask_b32 v228, v228, v213, vcc
    s_branch c_ok_t3
standalone__molecular_angular_gemnet__graph_kernel_end:
    s_endpgm

.section .rodata,"a"
.p2align 6
.amdhsa_kernel standalone__molecular_angular_gemnet__graph_kernel
  .amdhsa_next_free_vgpr 256
  .amdhsa_next_free_sgpr 102
  .amdhsa_accum_offset 256
  .amdhsa_group_segment_fixed_size 0
  .amdhsa_kernarg_size 112
  .amdhsa_user_sgpr_count 2
  .amdhsa_user_sgpr_kernarg_segment_ptr 1
  .amdhsa_system_sgpr_workgroup_id_x 1
.end_amdhsa_kernel
```
